```python
import torch

def _softmax(x, axis=-1):
    return torch.softmax(x, dim=axis)
def _gelu(x):
    return torch.nn.functional.gelu(x, approximate="tanh")
def _silu(x):
    return torch.nn.functional.silu(x)
def _sigmoid(x):
    return torch.sigmoid(x)
def _layernorm(x, axis=-1, eps=1e-5):
    m = x.mean(dim=axis, keepdim=True)
    v = x.var(dim=axis, keepdim=True, unbiased=False)
    return (x - m) / torch.sqrt(v + eps)
def _scatter_add(tgt, idx, src, axis=0):
    return tgt.clone().index_add_(axis, idx, src)
def _segment_sum(src, seg, n):
    out = torch.zeros((n,) + src.shape[1:], dtype=src.dtype)
    return out.index_add_(0, seg, src)
def _pad(x, pw):
    flat = tuple(v for pair in reversed(pw) for v in pair)
    return torch.nn.functional.pad(x, flat)

kernel_name = 'sequential_preLN__ssm_conv_s4__dense_activation_mish__prompt'

def setup_inputs():

    _w = (lambda a: (lambda t: t.to(torch.bfloat16) if t.is_floating_point() else t)(torch.as_tensor(a)))
    def _A_setup():
        B, L, D, N = 1, 2048, 640, 128
        A_re = -(lambda _x: torch.exp(torch.as_tensor(_x)))((lambda *s: torch.randn(*s, dtype=torch.bfloat16) * 6.4)(D, N))
        A_im = torch.pi * (lambda *s: torch.randn(*s, dtype=torch.bfloat16) * 0.05)(D, N)
        B_re = (lambda *s: torch.randn(*s, dtype=torch.bfloat16) * 0.1)(D, N)
        B_im = (lambda *s: torch.randn(*s, dtype=torch.bfloat16) * 0.1)(D, N)
        C_re = (lambda *s: torch.randn(*s, dtype=torch.bfloat16) * 0.1)(D, N)
        C_im = (lambda *s: torch.randn(*s, dtype=torch.bfloat16) * 0.1)(D, N)
        log_dt = (lambda *s: torch.randn(*s, dtype=torch.bfloat16) * 0.05)(D) * 0.5 - 4.0
        Dskip = (lambda *s: torch.randn(*s, dtype=torch.bfloat16) * 0.05)(D)
        return {
            "u": _w((lambda *s: torch.randn(*s, dtype=torch.bfloat16) * 0.05)(B, L, D)),
            "A_re": _w(A_re),
            "A_im": _w(A_im),
            "B_re": _w(B_re),
            "B_im": _w(B_im),
            "C_re": _w(C_re),
            "C_im": _w(C_im),
            "log_dt": _w(log_dt),
            "Dskip": _w(Dskip),
        }
    _A_in = _A_setup()

    def _B_setup():
        B, S, D, F = 1, 2048, 640, 1728
        return {
            "x": _w((lambda *s: torch.randn(*s, dtype=torch.bfloat16) * 0.05)(B, S, D)),
            "w1": _w((lambda *s: torch.randn(*s, dtype=torch.bfloat16) * 0.8)(D, F) * (D ** -0.5)),
            "b1": _w((lambda *s: torch.randn(*s, dtype=torch.bfloat16) * 0.2)(F)),
            "w2": _w((lambda *s: torch.randn(*s, dtype=torch.bfloat16) * 0.2)(F, D) * (F ** -0.5)),
        }
    _B_in = _B_setup()

    return {
        "A_u": _A_in["u"],
        "A_A_re": _A_in["A_re"],
        "A_A_im": _A_in["A_im"],
        "A_B_re": _A_in["B_re"],
        "A_B_im": _A_in["B_im"],
        "A_C_re": _A_in["C_re"],
        "A_C_im": _A_in["C_im"],
        "A_log_dt": _A_in["log_dt"],
        "A_Dskip": _A_in["Dskip"],
        "B_x": _B_in["x"],
        "B_w1": _B_in["w1"],
        "B_b1": _B_in["b1"],
        "B_w2": _B_in["w2"],
    }

def reference(A_u, A_A_re, A_A_im, A_B_re, A_B_im, A_C_re, A_C_im, A_log_dt, A_Dskip, B_x, B_w1, B_b1, B_w2):
    def _A_ref(u, A_re, A_im, B_re, B_im, C_re, C_im, log_dt, Dskip):
        Bsz, L, D = u.shape
        dt = torch.exp(log_dt)[:, None]
        A = A_re + 1j * A_im
        Bc = B_re + 1j * B_im
        Cc = C_re + 1j * C_im
        logdA = dt * A
        dB = dt * Bc
        l = (lambda x, dt: x.to(dt))(torch.arange(L), A_re.dtype)
        P = torch.exp(logdA[:, :, None] * l[None, None, :])
        K = torch.einsum("dn,dnl,dn->dl", Cc, P, dB).real
        L2 = 2 * L
        Kp = _pad(K, ((0, 0), (0, L)))
        up = (lambda x, *d: x.permute(*d))(u, 0, 2, 1)
        up = _pad(up, ((0, 0), (0, 0), (0, L)))
        Kf = (lambda x, axes=(-2,-1): torch.fft.rfft2(x.float(), dim=axes))(Kp[:, None, :], axes=(-2, -1))
        Uf = (lambda x, axes=(-2,-1): torch.fft.rfft2(x.float(), dim=axes))(up[:, :, None, :], axes=(-2, -1))
        Yf = Uf * Kf[None, :, :, :]
        y = (lambda x, s, axes=(-2,-1): torch.fft.irfft2(x, s=s, dim=axes).to(torch.bfloat16))(Yf, (1, L2), axes=(-2, -1))[:, :, 0, :L]
        y = (lambda x, *d: x.permute(*d))(y, 0, 2, 1) + u * Dskip[None, None, :]
        return y

    def _B_ref(x, w1, b1, w2):
        h = torch.einsum("bsd,df->bsf", x, w1) + b1
        sp = torch.log1p(torch.exp(-torch.abs(h))) + torch.where(h > 0, h, torch.zeros_like(h))
        act = h * torch.tanh(sp)
        return torch.einsum("bsf,fd->bsd", act, w2)

    x = A_u
    h = x + _A_ref(_layernorm(x, axis=-1), A_A_re, A_A_im, A_B_re, A_B_im, A_C_re, A_C_im, A_log_dt, A_Dskip)
    h2 = h + _B_ref(_layernorm(h, axis=-1), B_w1, B_b1, B_w2)
    return h2
```

```asm
; @launch grid=(256,1,1) block=(256,1,1) lds=163840
.amdgcn_target "amdgcn-amd-amdhsa--gfx950"
.text
.globl sequential_preLN__ssm_conv_s4__dense_activation_mish__prompt_kernel
.p2align 8
.type sequential_preLN__ssm_conv_s4__dense_activation_mish__prompt_kernel,@function
sequential_preLN__ssm_conv_s4__dense_activation_mish__prompt_kernel:
  s_cmp_ge_u32 s2, 256
  s_cbranch_scc1 mk_end
  s_load_dwordx16 s[32:47], s[0:1], 0
  s_load_dwordx16 s[48:63], s[0:1], 64
  s_cmp_lt_u32 s2, 248
  s_cbranch_scc1 mk_nopf
  s_getpc_b64 s[64:65]
mk_pc:
  v_lshlrev_b32 v5, 7, v0
  v_min_u32 v10, mk_codeend - mk_pc - 4, v5
  v_mov_b32 v7, s65
  v_add_co_u32 v6, vcc, s64, v10
  s_nop 1
  v_addc_co_u32 v7, vcc, 0, v7, vcc
  global_load_dword v250, v[6:7], off
  v_add_u32 v5, 32768, v5
  v_min_u32 v5, mk_codeend - mk_pc - 4, v5
  v_mov_b32 v9, s65
  v_add_co_u32 v8, vcc, s64, v5
  s_nop 1
  v_addc_co_u32 v9, vcc, 0, v9, vcc
  global_load_dword v251, v[8:9], off
mk_nopf:
  v_and_b32 v1, 63, v0
  v_lshrrev_b32 v4, 6, v0
  v_and_b32 v2, 15, v1
  v_lshrrev_b32 v3, 4, v1
  v_readfirstlane_b32 s3, v4
  s_waitcnt lgkmcnt(0)
  s_mov_b32 s8, s62
  s_mov_b32 s9, s63
  s_mov_b32 s10, 14611456
  s_mov_b32 s11, 0x00020000
  s_mov_b32 s12, s60
  s_mov_b32 s13, s61
  s_mov_b32 s14, 256
  s_mov_b32 s15, 0x00020000
  s_mov_b32 s16, s32
  s_mov_b32 s17, s33
  s_mov_b32 s18, 2621440
  s_mov_b32 s19, 0x00020000
  s_mov_b32 s20, s58
  s_mov_b32 s21, s59
  s_mov_b32 s22, 2621440
  s_mov_b32 s23, 0x00020000
  s_mov_b32 s24, s52
  s_mov_b32 s25, s53
  s_mov_b32 s26, 2211840
  s_mov_b32 s27, 0x00020000
  s_and_b32 s50, s2, 7
  s_lshr_b32 s50, s50, 1
  s_lshl_b32 s50, s50, 2
  s_lshr_b32 s64, s2, 3
  s_and_b32 s64, s64, 3
  s_add_u32 s50, s50, s64
  s_and_b32 s51, s2, 1
  s_lshl_b32 s51, s51, 3
  s_lshr_b32 s64, s2, 5
  s_add_u32 s51, s51, s64
  s_mul_i32 s51, s51, 7
  s_min_u32 s51, s51, 101
  s_cmp_lt_u32 s2, 160
  s_cbranch_scc1 mk_roleA
  s_sub_u32 s4, s2, 160
  s_cmp_ge_u32 s4, 64
  s_cbranch_scc1 prep_nostats
  s_cmp_lg_u32 s4, 0
  s_cbranch_scc1 prep_nz
  s_cmp_lg_u32 s3, 3
  s_cbranch_scc1 prep_nz
  v_mov_b32 v64, 0
  v_mov_b32 v65, 0
  v_mov_b32 v66, 0
  v_mov_b32 v67, 0
  v_lshlrev_b32 v68, 4, v1
  s_mov_b32 s64, 14598144
  buffer_store_dwordx4 v[64:67], v68, s[8:11], s64 offen sc1
  s_add_u32 s64, s64, 1024
  buffer_store_dwordx4 v[64:67], v68, s[8:11], s64 offen sc1
  s_add_u32 s64, s64, 1024
  buffer_store_dwordx4 v[64:67], v68, s[8:11], s64 offen sc1
  s_add_u32 s64, s64, 1024
  buffer_store_dwordx4 v[64:67], v68, s[8:11], s64 offen sc1
  s_add_u32 s64, s64, 1024
  buffer_store_dwordx4 v[64:67], v68, s[8:11], s64 offen sc1
  s_add_u32 s64, s64, 1024
  buffer_store_dwordx4 v[64:67], v68, s[8:11], s64 offen sc1
  s_add_u32 s64, s64, 1024
  buffer_store_dwordx4 v[64:67], v68, s[8:11], s64 offen sc1
  s_add_u32 s64, s64, 1024
  buffer_store_dwordx4 v[64:67], v68, s[8:11], s64 offen sc1
  s_add_u32 s64, s64, 1024
  buffer_store_dwordx4 v[64:67], v68, s[8:11], s64 offen sc1
  s_add_u32 s64, s64, 1024
  buffer_store_dwordx4 v[64:67], v68, s[8:11], s64 offen sc1
  s_add_u32 s64, s64, 1024
  buffer_store_dwordx4 v[64:67], v68, s[8:11], s64 offen sc1
  s_add_u32 s64, s64, 1024
  buffer_store_dwordx4 v[64:67], v68, s[8:11], s64 offen sc1
  s_add_u32 s64, s64, 1024
  buffer_store_dwordx4 v[64:67], v68, s[8:11], s64 offen sc1
prep_nz:
  v_mul_u32_u24 v6, 1280, v3
  v_lshl_add_u32 v6, v2, 4, v6
  s_lshl_b32 s64, s4, 5
  s_lshl_b32 s65, s3, 3
  s_add_u32 s64, s64, s65
  s_mul_i32 s65, s64, 1280
  s_add_u32 s66, s65, 5120
  buffer_load_dwordx4 v[16:19], v6, s[16:19], s65 offen offset:0
  buffer_load_dwordx4 v[20:23], v6, s[16:19], s65 offen offset:256
  buffer_load_dwordx4 v[24:27], v6, s[16:19], s65 offen offset:512
  buffer_load_dwordx4 v[28:31], v6, s[16:19], s65 offen offset:768
  buffer_load_dwordx4 v[32:35], v6, s[16:19], s65 offen offset:1024
  buffer_load_dwordx4 v[36:39], v6, s[16:19], s66 offen offset:0
  buffer_load_dwordx4 v[40:43], v6, s[16:19], s66 offen offset:256
  buffer_load_dwordx4 v[44:47], v6, s[16:19], s66 offen offset:512
  buffer_load_dwordx4 v[48:51], v6, s[16:19], s66 offen offset:768
  buffer_load_dwordx4 v[52:55], v6, s[16:19], s66 offen offset:1024
  s_mov_b32 s67, 0x3f803f80
  v_lshlrev_b32 v7, 3, v3
  s_lshl_b32 s68, s64, 3
  s_add_u32 s68, s68, 0
  v_mul_u32_u24 v8, 1296, v3
  v_lshl_add_u32 v8, v2, 4, v8
  s_mul_i32 s69, s3, 10368
  v_add_u32 v8, s69, v8
  v_mul_u32_u24 v10, 2592, v2
  v_lshl_add_u32 v10, v3, 3, v10
  s_mul_i32 s69, s3, 320
  v_add_u32 v10, s69, v10
  v_lshlrev_b32 v9, 14, v3
  v_lshl_add_u32 v9, v2, 4, v9
  s_mul_i32 s69, s3, 655360
  s_lshl_b32 s70, s4, 8
  s_add_u32 s69, s69, s70
  s_add_u32 s69, s69, 11976704
  v_cmp_eq_u32 s[72:73], 0, v2
  v_mov_b32 v60, 0
  v_mov_b32 v61, 0
  v_mov_b32 v62, 0
  v_mov_b32 v63, 0
  v_mov_b32 v64, 0
  v_mov_b32 v65, 0
  v_mov_b32 v66, 0
  v_mov_b32 v67, 0
  s_waitcnt vmcnt(5)
  s_waitcnt vmcnt(0)
  v_dot2_f32_bf16 v60, v16, s67, v60
  v_dot2_f32_bf16 v62, v16, v16, v62
  v_dot2_f32_bf16 v64, v36, s67, v64
  v_dot2_f32_bf16 v66, v36, v36, v66
  v_dot2_f32_bf16 v61, v17, s67, v61
  v_dot2_f32_bf16 v63, v17, v17, v63
  v_dot2_f32_bf16 v65, v37, s67, v65
  v_dot2_f32_bf16 v67, v37, v37, v67
  v_dot2_f32_bf16 v60, v18, s67, v60
  v_dot2_f32_bf16 v62, v18, v18, v62
  v_dot2_f32_bf16 v64, v38, s67, v64
  v_dot2_f32_bf16 v66, v38, v38, v66
  v_dot2_f32_bf16 v61, v19, s67, v61
  v_dot2_f32_bf16 v63, v19, v19, v63
  v_dot2_f32_bf16 v65, v39, s67, v65
  v_dot2_f32_bf16 v67, v39, v39, v67
  v_dot2_f32_bf16 v60, v20, s67, v60
  v_dot2_f32_bf16 v62, v20, v20, v62
  v_dot2_f32_bf16 v64, v40, s67, v64
  v_dot2_f32_bf16 v66, v40, v40, v66
  v_dot2_f32_bf16 v61, v21, s67, v61
  v_dot2_f32_bf16 v63, v21, v21, v63
  v_dot2_f32_bf16 v65, v41, s67, v65
  v_dot2_f32_bf16 v67, v41, v41, v67
  v_dot2_f32_bf16 v60, v22, s67, v60
  v_dot2_f32_bf16 v62, v22, v22, v62
  v_dot2_f32_bf16 v64, v42, s67, v64
  v_dot2_f32_bf16 v66, v42, v42, v66
  v_dot2_f32_bf16 v61, v23, s67, v61
  v_dot2_f32_bf16 v63, v23, v23, v63
  v_dot2_f32_bf16 v65, v43, s67, v65
  v_dot2_f32_bf16 v67, v43, v43, v67
  v_dot2_f32_bf16 v60, v24, s67, v60
  v_dot2_f32_bf16 v62, v24, v24, v62
  v_dot2_f32_bf16 v64, v44, s67, v64
  v_dot2_f32_bf16 v66, v44, v44, v66
  v_dot2_f32_bf16 v61, v25, s67, v61
  v_dot2_f32_bf16 v63, v25, v25, v63
  v_dot2_f32_bf16 v65, v45, s67, v65
  v_dot2_f32_bf16 v67, v45, v45, v67
  v_dot2_f32_bf16 v60, v26, s67, v60
  v_dot2_f32_bf16 v62, v26, v26, v62
  v_dot2_f32_bf16 v64, v46, s67, v64
  v_dot2_f32_bf16 v66, v46, v46, v66
  v_dot2_f32_bf16 v61, v27, s67, v61
  v_dot2_f32_bf16 v63, v27, v27, v63
  v_dot2_f32_bf16 v65, v47, s67, v65
  v_dot2_f32_bf16 v67, v47, v47, v67
  v_dot2_f32_bf16 v60, v28, s67, v60
  v_dot2_f32_bf16 v62, v28, v28, v62
  v_dot2_f32_bf16 v64, v48, s67, v64
  v_dot2_f32_bf16 v66, v48, v48, v66
  v_dot2_f32_bf16 v61, v29, s67, v61
  v_dot2_f32_bf16 v63, v29, v29, v63
  v_dot2_f32_bf16 v65, v49, s67, v65
  v_dot2_f32_bf16 v67, v49, v49, v67
  v_dot2_f32_bf16 v60, v30, s67, v60
  v_dot2_f32_bf16 v62, v30, v30, v62
  v_dot2_f32_bf16 v64, v50, s67, v64
  v_dot2_f32_bf16 v66, v50, v50, v66
  v_dot2_f32_bf16 v61, v31, s67, v61
  v_dot2_f32_bf16 v63, v31, v31, v63
  v_dot2_f32_bf16 v65, v51, s67, v65
  v_dot2_f32_bf16 v67, v51, v51, v67
  v_dot2_f32_bf16 v60, v32, s67, v60
  v_dot2_f32_bf16 v62, v32, v32, v62
  v_dot2_f32_bf16 v64, v52, s67, v64
  v_dot2_f32_bf16 v66, v52, v52, v66
  v_dot2_f32_bf16 v61, v33, s67, v61
  v_dot2_f32_bf16 v63, v33, v33, v63
  v_dot2_f32_bf16 v65, v53, s67, v65
  v_dot2_f32_bf16 v67, v53, v53, v67
  v_dot2_f32_bf16 v60, v34, s67, v60
  v_dot2_f32_bf16 v62, v34, v34, v62
  v_dot2_f32_bf16 v64, v54, s67, v64
  v_dot2_f32_bf16 v66, v54, v54, v66
  v_dot2_f32_bf16 v61, v35, s67, v61
  v_dot2_f32_bf16 v63, v35, v35, v63
  v_dot2_f32_bf16 v65, v55, s67, v65
  v_dot2_f32_bf16 v67, v55, v55, v67
  s_nop 1
  v_add_f32 v60, v60, v61
  v_add_f32 v64, v64, v65
  v_add_f32 v61, v62, v63
  v_add_f32 v65, v66, v67
  s_nop 0
  v_add_f32_dpp v62, v60, v60 quad_perm:[1,0,3,2] row_mask:0xf bank_mask:0xf
  v_add_f32_dpp v63, v61, v61 quad_perm:[1,0,3,2] row_mask:0xf bank_mask:0xf
  v_add_f32_dpp v66, v64, v64 quad_perm:[1,0,3,2] row_mask:0xf bank_mask:0xf
  v_add_f32_dpp v67, v65, v65 quad_perm:[1,0,3,2] row_mask:0xf bank_mask:0xf
  v_add_f32_dpp v60, v62, v62 quad_perm:[2,3,0,1] row_mask:0xf bank_mask:0xf
  v_add_f32_dpp v61, v63, v63 quad_perm:[2,3,0,1] row_mask:0xf bank_mask:0xf
  v_add_f32_dpp v64, v66, v66 quad_perm:[2,3,0,1] row_mask:0xf bank_mask:0xf
  v_add_f32_dpp v65, v67, v67 quad_perm:[2,3,0,1] row_mask:0xf bank_mask:0xf
  v_add_f32_dpp v62, v60, v60 row_half_mirror row_mask:0xf bank_mask:0xf
  v_add_f32_dpp v63, v61, v61 row_half_mirror row_mask:0xf bank_mask:0xf
  v_add_f32_dpp v66, v64, v64 row_half_mirror row_mask:0xf bank_mask:0xf
  v_add_f32_dpp v67, v65, v65 row_half_mirror row_mask:0xf bank_mask:0xf
  v_add_f32_dpp v60, v62, v62 row_mirror row_mask:0xf bank_mask:0xf
  v_add_f32_dpp v61, v63, v63 row_mirror row_mask:0xf bank_mask:0xf
  v_add_f32_dpp v64, v66, v66 row_mirror row_mask:0xf bank_mask:0xf
  v_add_f32_dpp v65, v67, v67 row_mirror row_mask:0xf bank_mask:0xf
  v_mul_f32 v60, 0x3acccccd, v60
  v_mul_f32 v64, 0x3acccccd, v64
  v_mul_f32 v61, 0x3acccccd, v61
  v_mul_f32 v65, 0x3acccccd, v65
  v_fma_f32 v61, -v60, v60, v61
  v_fma_f32 v65, -v64, v64, v65
  v_max_f32 v61, 0, v61
  v_max_f32 v65, 0, v65
  v_cvt_pk_bf16_f32 v61, v61, v61
  v_cvt_pk_bf16_f32 v65, v65, v65
  v_lshlrev_b32 v61, 16, v61
  v_lshlrev_b32 v65, 16, v65
  v_add_f32 v61, 0x3727c5ac, v61
  v_add_f32 v65, 0x3727c5ac, v65
  v_cvt_pk_bf16_f32 v61, v61, v61
  v_cvt_pk_bf16_f32 v65, v65, v65
  v_lshlrev_b32 v61, 16, v61
  v_lshlrev_b32 v65, 16, v65
  v_sqrt_f32 v61, v61
  v_sqrt_f32 v65, v65
  v_cvt_pk_bf16_f32 v60, v60, v60
  v_cvt_pk_bf16_f32 v64, v64, v64
  v_cvt_pk_bf16_f32 v61, v61, v61
  v_cvt_pk_bf16_f32 v65, v65, v65
  v_lshlrev_b32 v62, 16, v60
  v_lshlrev_b32 v66, 16, v64
  v_lshlrev_b32 v61, 16, v61
  v_lshlrev_b32 v65, 16, v65
  v_rcp_f32 v63, v61
  v_rcp_f32 v67, v65
  s_and_saveexec_b64 s[70:71], s[72:73]
  buffer_store_dwordx2 v[62:63], v7, s[8:11], s68 offen sc1
  buffer_store_dwordx2 v[66:67], v7, s[8:11], s68 offen offset:32 sc1
  s_mov_b64 exec, s[70:71]
  s_waitcnt vmcnt(0)
  s_mov_b32 s64, 0
  s_waitcnt vmcnt(0)
  s_barrier
  s_cmp_lg_u32 s3, 0
  s_cbranch_scc1 sequential_preLN__ssm_conv_s4__dense_activation_mish__prompt_kernel_arr_1
  v_mov_b32 v4, 1
  v_mov_b32 v7, 0
  s_mov_b64 exec, 1
  buffer_atomic_add v4, v7, s[12:15], s64 offen sc0
  s_waitcnt vmcnt(0)
  v_readfirstlane_b32 s67, v4
  s_cmp_lg_u32 s67, 63
  s_cbranch_scc1 sequential_preLN__ssm_conv_s4__dense_activation_mish__prompt_kernel_arr_1_x
  v_mov_b32 v4, 1
  s_mov_b32 s66, 128
  buffer_store_dword v4, v7, s[12:15], s66 offen sc1
sequential_preLN__ssm_conv_s4__dense_activation_mish__prompt_kernel_arr_1_x:
  s_mov_b64 exec, -1
sequential_preLN__ssm_conv_s4__dense_activation_mish__prompt_kernel_arr_1:
  s_mov_b32 s74, s4
  s_cmp_lt_u32 s4, 42
  s_cbranch_scc1 prep_cs
  s_sub_u32 s5, s4, 10
  s_mov_b32 s74, -1
  s_branch prep_w2
prep_nostats:
  s_sub_u32 s5, s4, 64
  s_add_u32 s74, s5, 42
  s_cmp_lt_u32 s5, 14
  s_cselect_b32 s74, s74, -1
prep_w2:
  s_mov_b32 s28, s56
  s_mov_b32 s29, s57
  s_mov_b32 s30, 2211840
  s_mov_b32 s31, 0x00020000
  v_lshlrev_b32 v15, 4, v1
  s_mul_i32 s64, s5, 40960
  s_mul_i32 s65, s3, 10240
  s_add_u32 s64, s64, s65
  s_add_u32 m0, s65, 0
  s_add_u32 s68, s64, 0
  buffer_load_dwordx4 v15, s[28:31], s68 offen nt lds
  s_add_u32 m0, s65, 1024
  s_add_u32 s68, s64, 1024
  buffer_load_dwordx4 v15, s[28:31], s68 offen nt lds
  s_add_u32 m0, s65, 2048
  s_add_u32 s68, s64, 2048
  buffer_load_dwordx4 v15, s[28:31], s68 offen nt lds
  s_add_u32 m0, s65, 3072
  s_add_u32 s68, s64, 3072
  buffer_load_dwordx4 v15, s[28:31], s68 offen nt lds
  s_add_u32 m0, s65, 4096
  s_add_u32 s68, s64, 4096
  buffer_load_dwordx4 v15, s[28:31], s68 offen nt lds
  s_add_u32 m0, s65, 5120
  s_add_u32 s68, s64, 5120
  buffer_load_dwordx4 v15, s[28:31], s68 offen nt lds
  s_add_u32 m0, s65, 6144
  s_add_u32 s68, s64, 6144
  buffer_load_dwordx4 v15, s[28:31], s68 offen nt lds
  s_add_u32 m0, s65, 7168
  s_add_u32 s68, s64, 7168
  buffer_load_dwordx4 v15, s[28:31], s68 offen nt lds
  s_add_u32 m0, s65, 8192
  s_add_u32 s68, s64, 8192
  buffer_load_dwordx4 v15, s[28:31], s68 offen nt lds
  s_add_u32 m0, s65, 9216
  s_add_u32 s68, s64, 9216
  buffer_load_dwordx4 v15, s[28:31], s68 offen nt lds
  v_lshrrev_b32 v12, 2, v1
  v_mul_u32_u24 v12, 1280, v12
  s_mul_i32 s68, s3, 320
  v_add_u32 v12, s68, v12
  v_and_b32 v14, 3, v1
  v_lshl_add_u32 v13, v14, 3, v12
  v_lshl_add_u32 v12, v14, 4, v12
  s_waitcnt vmcnt(0)
  s_barrier
  ds_read_b64_tr_b16 v[16:17], v12 offset:0
  ds_read_b64_tr_b16 v[18:19], v12 offset:20480
  ds_read_b64_tr_b16 v[20:21], v12 offset:8
  ds_read_b64_tr_b16 v[22:23], v12 offset:20488
  ds_read_b64_tr_b16 v[24:25], v12 offset:64
  ds_read_b64_tr_b16 v[26:27], v12 offset:20544
  ds_read_b64_tr_b16 v[28:29], v12 offset:72
  ds_read_b64_tr_b16 v[30:31], v12 offset:20552
  ds_read_b64_tr_b16 v[32:33], v13 offset:128
  ds_read_b64_tr_b16 v[34:35], v13 offset:20608
  ds_read_b64_tr_b16 v[36:37], v12 offset:160
  ds_read_b64_tr_b16 v[38:39], v12 offset:20640
  ds_read_b64_tr_b16 v[40:41], v12 offset:168
  ds_read_b64_tr_b16 v[42:43], v12 offset:20648
  ds_read_b64_tr_b16 v[44:45], v12 offset:224
  ds_read_b64_tr_b16 v[46:47], v12 offset:20704
  ds_read_b64_tr_b16 v[48:49], v12 offset:232
  ds_read_b64_tr_b16 v[50:51], v12 offset:20712
  ds_read_b64_tr_b16 v[52:53], v13 offset:288
  ds_read_b64_tr_b16 v[54:55], v13 offset:20768
  s_mul_i32 s68, s3, 552960
  s_lshl_b32 s69, s5, 10
  s_add_u32 s68, s68, s69
  s_add_u32 s68, s68, 65536
  s_waitcnt lgkmcnt(15)
  buffer_store_dwordx4 v[16:19], v15, s[8:11], s68 offen sc1
  s_add_u32 s68, s68, 55296
  s_waitcnt lgkmcnt(15)
  buffer_store_dwordx4 v[20:23], v15, s[8:11], s68 offen sc1
  s_add_u32 s68, s68, 55296
  s_waitcnt lgkmcnt(14)
  buffer_store_dwordx4 v[24:27], v15, s[8:11], s68 offen sc1
  s_add_u32 s68, s68, 55296
  s_waitcnt lgkmcnt(12)
  buffer_store_dwordx4 v[28:31], v15, s[8:11], s68 offen sc1
  s_add_u32 s68, s68, 55296
  s_waitcnt lgkmcnt(10)
  buffer_store_dwordx4 v[32:35], v15, s[8:11], s68 offen sc1
  s_add_u32 s68, s68, 55296
  s_waitcnt lgkmcnt(8)
  buffer_store_dwordx4 v[36:39], v15, s[8:11], s68 offen sc1
  s_add_u32 s68, s68, 55296
  s_waitcnt lgkmcnt(6)
  buffer_store_dwordx4 v[40:43], v15, s[8:11], s68 offen sc1
  s_add_u32 s68, s68, 55296
  s_waitcnt lgkmcnt(4)
  buffer_store_dwordx4 v[44:47], v15, s[8:11], s68 offen sc1
  s_add_u32 s68, s68, 55296
  s_waitcnt lgkmcnt(2)
  buffer_store_dwordx4 v[48:51], v15, s[8:11], s68 offen sc1
  s_add_u32 s68, s68, 55296
  s_waitcnt lgkmcnt(0)
  buffer_store_dwordx4 v[52:55], v15, s[8:11], s68 offen sc1
  s_cmp_eq_u32 s74, -1
  s_cbranch_scc1 prep_fill
prep_cs:
  s_mul_i32 s64, s74, 4682
  s_lshr_b32 s64, s64, 16
  s_mul_i32 s65, s64, 14
  s_sub_u32 s65, s74, s65
  s_mul_i32 s66, s64, 160
  s_mul_i32 s67, s3, 40
  s_add_u32 s66, s66, s67
  s_mul_i32 s66, s66, 3456
  s_lshl_b32 s67, s65, 8
  s_add_u32 s66, s66, s67
  v_lshlrev_b32 v6, 2, v1
  buffer_load_dword v64, v6, s[24:27], s66 offen
  s_add_u32 s66, s66, 3456
  buffer_load_dword v65, v6, s[24:27], s66 offen
  s_add_u32 s66, s66, 3456
  buffer_load_dword v66, v6, s[24:27], s66 offen
  s_add_u32 s66, s66, 3456
  buffer_load_dword v67, v6, s[24:27], s66 offen
  s_add_u32 s66, s66, 3456
  buffer_load_dword v68, v6, s[24:27], s66 offen
  s_add_u32 s66, s66, 3456
  buffer_load_dword v69, v6, s[24:27], s66 offen
  s_add_u32 s66, s66, 3456
  buffer_load_dword v70, v6, s[24:27], s66 offen
  s_add_u32 s66, s66, 3456
  buffer_load_dword v71, v6, s[24:27], s66 offen
  s_add_u32 s66, s66, 3456
  buffer_load_dword v72, v6, s[24:27], s66 offen
  s_add_u32 s66, s66, 3456
  buffer_load_dword v73, v6, s[24:27], s66 offen
  s_add_u32 s66, s66, 3456
  buffer_load_dword v74, v6, s[24:27], s66 offen
  s_add_u32 s66, s66, 3456
  buffer_load_dword v75, v6, s[24:27], s66 offen
  s_add_u32 s66, s66, 3456
  buffer_load_dword v76, v6, s[24:27], s66 offen
  s_add_u32 s66, s66, 3456
  buffer_load_dword v77, v6, s[24:27], s66 offen
  s_add_u32 s66, s66, 3456
  buffer_load_dword v78, v6, s[24:27], s66 offen
  s_add_u32 s66, s66, 3456
  buffer_load_dword v79, v6, s[24:27], s66 offen
  s_add_u32 s66, s66, 3456
  buffer_load_dword v80, v6, s[24:27], s66 offen
  s_add_u32 s66, s66, 3456
  buffer_load_dword v81, v6, s[24:27], s66 offen
  s_add_u32 s66, s66, 3456
  buffer_load_dword v82, v6, s[24:27], s66 offen
  s_add_u32 s66, s66, 3456
  buffer_load_dword v83, v6, s[24:27], s66 offen
  s_add_u32 s66, s66, 3456
  buffer_load_dword v84, v6, s[24:27], s66 offen
  s_add_u32 s66, s66, 3456
  buffer_load_dword v85, v6, s[24:27], s66 offen
  s_add_u32 s66, s66, 3456
  buffer_load_dword v86, v6, s[24:27], s66 offen
  s_add_u32 s66, s66, 3456
  buffer_load_dword v87, v6, s[24:27], s66 offen
  s_add_u32 s66, s66, 3456
  buffer_load_dword v88, v6, s[24:27], s66 offen
  s_add_u32 s66, s66, 3456
  buffer_load_dword v89, v6, s[24:27], s66 offen
  s_add_u32 s66, s66, 3456
  buffer_load_dword v90, v6, s[24:27], s66 offen
  s_add_u32 s66, s66, 3456
  buffer_load_dword v91, v6, s[24:27], s66 offen
  s_add_u32 s66, s66, 3456
  buffer_load_dword v92, v6, s[24:27], s66 offen
  s_add_u32 s66, s66, 3456
  buffer_load_dword v93, v6, s[24:27], s66 offen
  s_add_u32 s66, s66, 3456
  buffer_load_dword v94, v6, s[24:27], s66 offen
  s_add_u32 s66, s66, 3456
  buffer_load_dword v95, v6, s[24:27], s66 offen
  s_add_u32 s66, s66, 3456
  buffer_load_dword v96, v6, s[24:27], s66 offen
  s_add_u32 s66, s66, 3456
  buffer_load_dword v97, v6, s[24:27], s66 offen
  s_add_u32 s66, s66, 3456
  buffer_load_dword v98, v6, s[24:27], s66 offen
  s_add_u32 s66, s66, 3456
  buffer_load_dword v99, v6, s[24:27], s66 offen
  s_add_u32 s66, s66, 3456
  buffer_load_dword v100, v6, s[24:27], s66 offen
  s_add_u32 s66, s66, 3456
  buffer_load_dword v101, v6, s[24:27], s66 offen
  s_add_u32 s66, s66, 3456
  buffer_load_dword v102, v6, s[24:27], s66 offen
  s_add_u32 s66, s66, 3456
  buffer_load_dword v103, v6, s[24:27], s66 offen
  s_mov_b32 s67, 0x00003f80
  s_mov_b32 s68, 0x3f800000
  v_mov_b32 v60, 0
  v_mov_b32 v61, 0
  v_mov_b32 v62, 0
  v_mov_b32 v63, 0
  s_waitcnt vmcnt(30)
  v_dot2_f32_bf16 v60, v64, s67, v60
  v_dot2_f32_bf16 v61, v64, s68, v61
  v_dot2_f32_bf16 v62, v65, s67, v62
  v_dot2_f32_bf16 v63, v65, s68, v63
  v_dot2_f32_bf16 v60, v66, s67, v60
  v_dot2_f32_bf16 v61, v66, s68, v61
  v_dot2_f32_bf16 v62, v67, s67, v62
  v_dot2_f32_bf16 v63, v67, s68, v63
  v_dot2_f32_bf16 v60, v68, s67, v60
  v_dot2_f32_bf16 v61, v68, s68, v61
  v_dot2_f32_bf16 v62, v69, s67, v62
  v_dot2_f32_bf16 v63, v69, s68, v63
  v_dot2_f32_bf16 v60, v70, s67, v60
  v_dot2_f32_bf16 v61, v70, s68, v61
  v_dot2_f32_bf16 v62, v71, s67, v62
  v_dot2_f32_bf16 v63, v71, s68, v63
  v_dot2_f32_bf16 v60, v72, s67, v60
  v_dot2_f32_bf16 v61, v72, s68, v61
  v_dot2_f32_bf16 v62, v73, s67, v62
  v_dot2_f32_bf16 v63, v73, s68, v63
  s_waitcnt vmcnt(20)
  v_dot2_f32_bf16 v60, v74, s67, v60
  v_dot2_f32_bf16 v61, v74, s68, v61
  v_dot2_f32_bf16 v62, v75, s67, v62
  v_dot2_f32_bf16 v63, v75, s68, v63
  v_dot2_f32_bf16 v60, v76, s67, v60
  v_dot2_f32_bf16 v61, v76, s68, v61
  v_dot2_f32_bf16 v62, v77, s67, v62
  v_dot2_f32_bf16 v63, v77, s68, v63
  v_dot2_f32_bf16 v60, v78, s67, v60
  v_dot2_f32_bf16 v61, v78, s68, v61
  v_dot2_f32_bf16 v62, v79, s67, v62
  v_dot2_f32_bf16 v63, v79, s68, v63
  v_dot2_f32_bf16 v60, v80, s67, v60
  v_dot2_f32_bf16 v61, v80, s68, v61
  v_dot2_f32_bf16 v62, v81, s67, v62
  v_dot2_f32_bf16 v63, v81, s68, v63
  v_dot2_f32_bf16 v60, v82, s67, v60
  v_dot2_f32_bf16 v61, v82, s68, v61
  v_dot2_f32_bf16 v62, v83, s67, v62
  v_dot2_f32_bf16 v63, v83, s68, v63
  s_waitcnt vmcnt(10)
  v_dot2_f32_bf16 v60, v84, s67, v60
  v_dot2_f32_bf16 v61, v84, s68, v61
  v_dot2_f32_bf16 v62, v85, s67, v62
  v_dot2_f32_bf16 v63, v85, s68, v63
  v_dot2_f32_bf16 v60, v86, s67, v60
  v_dot2_f32_bf16 v61, v86, s68, v61
  v_dot2_f32_bf16 v62, v87, s67, v62
  v_dot2_f32_bf16 v63, v87, s68, v63
  v_dot2_f32_bf16 v60, v88, s67, v60
  v_dot2_f32_bf16 v61, v88, s68, v61
  v_dot2_f32_bf16 v62, v89, s67, v62
  v_dot2_f32_bf16 v63, v89, s68, v63
  v_dot2_f32_bf16 v60, v90, s67, v60
  v_dot2_f32_bf16 v61, v90, s68, v61
  v_dot2_f32_bf16 v62, v91, s67, v62
  v_dot2_f32_bf16 v63, v91, s68, v63
  v_dot2_f32_bf16 v60, v92, s67, v60
  v_dot2_f32_bf16 v61, v92, s68, v61
  v_dot2_f32_bf16 v62, v93, s67, v62
  v_dot2_f32_bf16 v63, v93, s68, v63
  s_waitcnt vmcnt(0)
  v_dot2_f32_bf16 v60, v94, s67, v60
  v_dot2_f32_bf16 v61, v94, s68, v61
  v_dot2_f32_bf16 v62, v95, s67, v62
  v_dot2_f32_bf16 v63, v95, s68, v63
  v_dot2_f32_bf16 v60, v96, s67, v60
  v_dot2_f32_bf16 v61, v96, s68, v61
  v_dot2_f32_bf16 v62, v97, s67, v62
  v_dot2_f32_bf16 v63, v97, s68, v63
  v_dot2_f32_bf16 v60, v98, s67, v60
  v_dot2_f32_bf16 v61, v98, s68, v61
  v_dot2_f32_bf16 v62, v99, s67, v62
  v_dot2_f32_bf16 v63, v99, s68, v63
  v_dot2_f32_bf16 v60, v100, s67, v60
  v_dot2_f32_bf16 v61, v100, s68, v61
  v_dot2_f32_bf16 v62, v101, s67, v62
  v_dot2_f32_bf16 v63, v101, s68, v63
  v_dot2_f32_bf16 v60, v102, s67, v60
  v_dot2_f32_bf16 v61, v102, s68, v61
  v_dot2_f32_bf16 v62, v103, s67, v62
  v_dot2_f32_bf16 v63, v103, s68, v63
  s_nop 2
  v_add_f32 v60, v60, v62
  v_add_f32 v61, v61, v63
  v_lshlrev_b32 v7, 3, v0
  ds_write_b64 v7, v[60:61] offset:49152
  s_waitcnt lgkmcnt(0)
  s_barrier
  v_lshlrev_b32 v7, 3, v1
  ds_read_b64 v[62:63], v7 offset:49152
  ds_read_b64 v[64:65], v7 offset:49664
  ds_read_b64 v[66:67], v7 offset:50176
  ds_read_b64 v[68:69], v7 offset:50688
  s_waitcnt lgkmcnt(0)
  v_add_f32 v62, v62, v64
  v_add_f32 v63, v63, v65
  v_add_f32 v66, v66, v68
  v_add_f32 v67, v67, v69
  v_add_f32 v62, v62, v66
  v_add_f32 v63, v63, v67
  s_mul_i32 s66, s64, 7168
  s_lshl_b32 s67, s65, 9
  s_add_u32 s66, s66, s67
  s_add_u32 s66, s66, 16384
  s_cmp_lg_u32 s3, 0
  s_cbranch_scc1 prep_fill
  buffer_store_dwordx2 v[62:63], v7, s[8:11], s66 offen sc1
prep_fill:
  s_mov_b32 s28, s62
  s_mov_b32 s29, s63
  s_mov_b32 s30, 4898816
  s_mov_b32 s31, 0x00020000
  v_mov_b32 v64, -1
  v_mov_b32 v65, -1
  v_mov_b32 v66, -1
  v_mov_b32 v67, -1
  v_lshlrev_b32 v68, 4, v1
  s_lshl_b32 s64, s4, 2
  s_add_u32 s64, s64, s3
  s_mul_i32 s64, s64, 7168
  s_add_u32 s64, s64, 2277376
  buffer_store_dwordx4 v[64:67], v68, s[28:31], s64 offen sc1
  s_add_u32 s64, s64, 1024
  buffer_store_dwordx4 v[64:67], v68, s[28:31], s64 offen sc1
  s_add_u32 s64, s64, 1024
  buffer_store_dwordx4 v[64:67], v68, s[28:31], s64 offen sc1
  s_add_u32 s64, s64, 1024
  buffer_store_dwordx4 v[64:67], v68, s[28:31], s64 offen sc1
  s_add_u32 s64, s64, 1024
  buffer_store_dwordx4 v[64:67], v68, s[28:31], s64 offen sc1
  s_add_u32 s64, s64, 1024
  buffer_store_dwordx4 v[64:67], v68, s[28:31], s64 offen sc1
  s_add_u32 s64, s64, 1024
  buffer_store_dwordx4 v[64:67], v68, s[28:31], s64 offen sc1
prep_done:
  s_mov_b32 s64, 64
  s_waitcnt vmcnt(0)
  s_barrier
  s_cmp_lg_u32 s3, 0
  s_cbranch_scc1 sequential_preLN__ssm_conv_s4__dense_activation_mish__prompt_kernel_arr_2
  v_mov_b32 v4, 1
  v_mov_b32 v7, 0
  s_mov_b64 exec, 1
  buffer_atomic_add v4, v7, s[12:15], s64 offen sc0
  s_waitcnt vmcnt(0)
  v_readfirstlane_b32 s67, v4
  s_cmp_lg_u32 s67, 95
  s_cbranch_scc1 sequential_preLN__ssm_conv_s4__dense_activation_mish__prompt_kernel_arr_2_x
  v_mov_b32 v4, 1
  s_mov_b32 s66, 132
  buffer_store_dword v4, v7, s[12:15], s66 offen sc1
sequential_preLN__ssm_conv_s4__dense_activation_mish__prompt_kernel_arr_2_x:
  s_mov_b64 exec, -1
sequential_preLN__ssm_conv_s4__dense_activation_mish__prompt_kernel_arr_2:
  s_lshr_b32 s64, s4, 3
  s_lshl_b32 s65, s64, 2
  s_add_u32 s65, s65, s3
  v_lshlrev_b32 v6, 4, v1
  v_add_u32 v8, 0, v1
  v_mul_u32_u24 v9, 4682, v8
  v_lshrrev_b32 v9, 16, v9
  v_mul_u32_u24 v10, 14, v9
  v_sub_u32 v8, v8, v10
  v_mul_u32_u24 v9, 3456, v9
  v_lshl_add_u32 v100, v8, 4, v9
  v_add_u32 v8, 64, v1
  v_mul_u32_u24 v9, 4682, v8
  v_lshrrev_b32 v9, 16, v9
  v_mul_u32_u24 v10, 14, v9
  v_sub_u32 v8, v8, v10
  v_mul_u32_u24 v9, 3456, v9
  v_lshl_add_u32 v101, v8, 4, v9
  v_add_u32 v8, 128, v1
  v_mul_u32_u24 v9, 4682, v8
  v_lshrrev_b32 v9, 16, v9
  v_mul_u32_u24 v10, 14, v9
  v_sub_u32 v8, v8, v10
  v_mul_u32_u24 v9, 3456, v9
  v_lshl_add_u32 v102, v8, 4, v9
  v_add_u32 v8, 192, v1
  v_mul_u32_u24 v9, 4682, v8
  v_lshrrev_b32 v9, 16, v9
  v_mul_u32_u24 v10, 14, v9
  v_sub_u32 v8, v8, v10
  v_mul_u32_u24 v9, 3456, v9
  v_lshl_add_u32 v103, v8, 4, v9
  v_add_u32 v8, 256, v1
  v_mul_u32_u24 v9, 4682, v8
  v_lshrrev_b32 v9, 16, v9
  v_mul_u32_u24 v10, 14, v9
  v_sub_u32 v8, v8, v10
  v_mul_u32_u24 v9, 3456, v9
  v_lshl_add_u32 v104, v8, 4, v9
  v_add_u32 v8, 320, v1
  v_mul_u32_u24 v9, 4682, v8
  v_lshrrev_b32 v9, 16, v9
  v_mul_u32_u24 v10, 14, v9
  v_sub_u32 v8, v8, v10
  v_mul_u32_u24 v9, 3456, v9
  v_lshl_add_u32 v105, v8, 4, v9
  v_add_u32 v8, 384, v1
  v_mul_u32_u24 v9, 4682, v8
  v_lshrrev_b32 v9, 16, v9
  v_mul_u32_u24 v10, 14, v9
  v_sub_u32 v8, v8, v10
  v_mul_u32_u24 v9, 3456, v9
  v_lshl_add_u32 v106, v8, 4, v9
  s_add_u32 s68, s3, 0
  s_mul_i32 s69, s68, 110592
  s_lshl_b32 s70, s51, 5
  s_add_u32 s69, s69, s70
  s_mul_i32 s70, s68, 7168
  s_add_u32 m0, s70, 0
  s_nop 0
  buffer_load_dwordx4 v100, s[24:27], s69 offen lds
  s_add_u32 m0, s70, 1024
  s_nop 0
  buffer_load_dwordx4 v101, s[24:27], s69 offen lds
  s_add_u32 m0, s70, 2048
  s_nop 0
  buffer_load_dwordx4 v102, s[24:27], s69 offen lds
  s_add_u32 m0, s70, 3072
  s_nop 0
  buffer_load_dwordx4 v103, s[24:27], s69 offen lds
  s_add_u32 m0, s70, 4096
  s_nop 0
  buffer_load_dwordx4 v104, s[24:27], s69 offen lds
  s_add_u32 m0, s70, 5120
  s_nop 0
  buffer_load_dwordx4 v105, s[24:27], s69 offen lds
  s_add_u32 m0, s70, 6144
  s_nop 0
  buffer_load_dwordx4 v106, s[24:27], s69 offen lds
  s_add_u32 s68, s3, 4
  s_mul_i32 s69, s68, 110592
  s_lshl_b32 s70, s51, 5
  s_add_u32 s69, s69, s70
  s_mul_i32 s70, s68, 7168
  s_add_u32 m0, s70, 0
  s_nop 0
  buffer_load_dwordx4 v100, s[24:27], s69 offen lds
  s_add_u32 m0, s70, 1024
  s_nop 0
  buffer_load_dwordx4 v101, s[24:27], s69 offen lds
  s_add_u32 m0, s70, 2048
  s_nop 0
  buffer_load_dwordx4 v102, s[24:27], s69 offen lds
  s_add_u32 m0, s70, 3072
  s_nop 0
  buffer_load_dwordx4 v103, s[24:27], s69 offen lds
  s_add_u32 m0, s70, 4096
  s_nop 0
  buffer_load_dwordx4 v104, s[24:27], s69 offen lds
  s_add_u32 m0, s70, 5120
  s_nop 0
  buffer_load_dwordx4 v105, s[24:27], s69 offen lds
  s_add_u32 m0, s70, 6144
  s_nop 0
  buffer_load_dwordx4 v106, s[24:27], s69 offen lds
  s_add_u32 s68, s3, 8
  s_mul_i32 s69, s68, 110592
  s_lshl_b32 s70, s51, 5
  s_add_u32 s69, s69, s70
  s_mul_i32 s70, s68, 7168
  s_add_u32 m0, s70, 0
  s_nop 0
  buffer_load_dwordx4 v100, s[24:27], s69 offen lds
  s_add_u32 m0, s70, 1024
  s_nop 0
  buffer_load_dwordx4 v101, s[24:27], s69 offen lds
  s_add_u32 m0, s70, 2048
  s_nop 0
  buffer_load_dwordx4 v102, s[24:27], s69 offen lds
  s_add_u32 m0, s70, 3072
  s_nop 0
  buffer_load_dwordx4 v103, s[24:27], s69 offen lds
  s_add_u32 m0, s70, 4096
  s_nop 0
  buffer_load_dwordx4 v104, s[24:27], s69 offen lds
  s_add_u32 m0, s70, 5120
  s_nop 0
  buffer_load_dwordx4 v105, s[24:27], s69 offen lds
  s_add_u32 m0, s70, 6144
  s_nop 0
  buffer_load_dwordx4 v106, s[24:27], s69 offen lds
  s_add_u32 s68, s3, 12
  s_mul_i32 s69, s68, 110592
  s_lshl_b32 s70, s51, 5
  s_add_u32 s69, s69, s70
  s_mul_i32 s70, s68, 7168
  s_add_u32 m0, s70, 0
  s_nop 0
  buffer_load_dwordx4 v100, s[24:27], s69 offen lds
  s_add_u32 m0, s70, 1024
  s_nop 0
  buffer_load_dwordx4 v101, s[24:27], s69 offen lds
  s_add_u32 m0, s70, 2048
  s_nop 0
  buffer_load_dwordx4 v102, s[24:27], s69 offen lds
  s_add_u32 m0, s70, 3072
  s_nop 0
  buffer_load_dwordx4 v103, s[24:27], s69 offen lds
  s_add_u32 m0, s70, 4096
  s_nop 0
  buffer_load_dwordx4 v104, s[24:27], s69 offen lds
  s_add_u32 m0, s70, 5120
  s_nop 0
  buffer_load_dwordx4 v105, s[24:27], s69 offen lds
  s_add_u32 m0, s70, 6144
  s_nop 0
  buffer_load_dwordx4 v106, s[24:27], s69 offen lds
  s_add_u32 s68, s3, 16
  s_mul_i32 s69, s68, 110592
  s_lshl_b32 s70, s51, 5
  s_add_u32 s69, s69, s70
  s_mul_i32 s70, s68, 7168
  s_add_u32 m0, s70, 0
  s_nop 0
  buffer_load_dwordx4 v100, s[24:27], s69 offen lds
  s_add_u32 m0, s70, 1024
  s_nop 0
  buffer_load_dwordx4 v101, s[24:27], s69 offen lds
  s_add_u32 m0, s70, 2048
  s_nop 0
  buffer_load_dwordx4 v102, s[24:27], s69 offen lds
  s_add_u32 m0, s70, 3072
  s_nop 0
  buffer_load_dwordx4 v103, s[24:27], s69 offen lds
  s_add_u32 m0, s70, 4096
  s_nop 0
  buffer_load_dwordx4 v104, s[24:27], s69 offen lds
  s_add_u32 m0, s70, 5120
  s_nop 0
  buffer_load_dwordx4 v105, s[24:27], s69 offen lds
  s_add_u32 m0, s70, 6144
  s_nop 0
  buffer_load_dwordx4 v106, s[24:27], s69 offen lds
  s_mul_i32 s66, s65, 13824
  s_and_b32 s67, s4, 1
  s_mul_i32 s67, s67, 1792
  s_add_u32 s66, s66, s67
  s_add_u32 s66, s66, 1658880
  buffer_load_dwordx4 v[128:131], v6, s[24:27], s66 offen
  buffer_load_dwordx4 v[132:135], v6, s[24:27], s66 offen offset:1024
  s_add_u32 s66, s66, 3456
  buffer_load_dwordx4 v[136:139], v6, s[24:27], s66 offen
  buffer_load_dwordx4 v[140:143], v6, s[24:27], s66 offen offset:1024
  s_add_u32 s66, s66, 3456
  buffer_load_dwordx4 v[144:147], v6, s[24:27], s66 offen
  buffer_load_dwordx4 v[148:151], v6, s[24:27], s66 offen offset:1024
  s_add_u32 s66, s66, 3456
  buffer_load_dwordx4 v[152:155], v6, s[24:27], s66 offen
  buffer_load_dwordx4 v[156:159], v6, s[24:27], s66 offen offset:1024
  s_mov_b32 s64, 132
  s_cmp_lg_u32 s3, 0
  s_cbranch_scc1 sequential_preLN__ssm_conv_s4__dense_activation_mish__prompt_kernel_pskip_5
  v_mov_b32 v7, 0
  s_mov_b64 exec, 1
  s_mov_b32 s66, 0
sequential_preLN__ssm_conv_s4__dense_activation_mish__prompt_kernel_poll_3:
  buffer_load_dword v4, v7, s[12:15], s64 offen sc1
  s_add_u32 s66, s66, 1
  s_waitcnt vmcnt(0)
  v_cmp_gt_u32 vcc, 1, v4
  s_cmp_gt_u32 s66, 400000
  s_cbranch_scc1 sequential_preLN__ssm_conv_s4__dense_activation_mish__prompt_kernel_polled_4
  s_cbranch_vccz sequential_preLN__ssm_conv_s4__dense_activation_mish__prompt_kernel_polled_4
  s_sleep 8
  s_branch sequential_preLN__ssm_conv_s4__dense_activation_mish__prompt_kernel_poll_3
sequential_preLN__ssm_conv_s4__dense_activation_mish__prompt_kernel_polled_4:
  s_mov_b64 exec, -1
sequential_preLN__ssm_conv_s4__dense_activation_mish__prompt_kernel_pskip_5:
  s_barrier
  s_mov_b32 s64, 128
  s_cmp_lg_u32 s3, 0
  s_cbranch_scc1 sequential_preLN__ssm_conv_s4__dense_activation_mish__prompt_kernel_pskip_8
  v_mov_b32 v7, 0
  s_mov_b64 exec, 1
  s_mov_b32 s66, 0
sequential_preLN__ssm_conv_s4__dense_activation_mish__prompt_kernel_poll_6:
  buffer_load_dword v4, v7, s[12:15], s64 offen sc1
  s_add_u32 s66, s66, 1
  s_waitcnt vmcnt(0)
  v_cmp_gt_u32 vcc, 1, v4
  s_cmp_gt_u32 s66, 400000
  s_cbranch_scc1 sequential_preLN__ssm_conv_s4__dense_activation_mish__prompt_kernel_polled_7
  s_cbranch_vccz sequential_preLN__ssm_conv_s4__dense_activation_mish__prompt_kernel_polled_7
  s_sleep 8
  s_branch sequential_preLN__ssm_conv_s4__dense_activation_mish__prompt_kernel_poll_6
sequential_preLN__ssm_conv_s4__dense_activation_mish__prompt_kernel_polled_7:
  s_mov_b64 exec, -1
sequential_preLN__ssm_conv_s4__dense_activation_mish__prompt_kernel_pskip_8:
  s_barrier
  s_cmp_lg_u32 s3, 1
  s_cbranch_scc1 prep_cb
  s_mov_b32 s28, s54
  s_mov_b32 s29, s55
  s_mov_b32 s30, 3456
  s_mov_b32 s31, 0x00020000
  v_lshlrev_b32 v91, 3, v1
  v_lshlrev_b32 v92, 2, v1
  s_lshl_b32 s66, s51, 6
  s_add_u32 s66, s66, 16384
  s_lshl_b32 s67, s51, 5
  buffer_load_dwordx2 v[82:83], v91, s[8:11], s66 offen sc1
  s_add_u32 s66, s66, 7168
  buffer_load_dwordx2 v[84:85], v91, s[8:11], s66 offen sc1
  s_add_u32 s66, s66, 7168
  buffer_load_dwordx2 v[86:87], v91, s[8:11], s66 offen sc1
  s_add_u32 s66, s66, 7168
  buffer_load_dwordx2 v[88:89], v91, s[8:11], s66 offen sc1
  buffer_load_dword v90, v92, s[28:31], s67 offen
  s_waitcnt vmcnt(0)
  v_add_f32 v82, v82, v84
  v_add_f32 v86, v86, v88
  v_add_f32 v82, v82, v86
  v_add_f32 v83, v83, v85
  v_add_f32 v87, v87, v89
  v_add_f32 v83, v83, v87
  v_and_b32 v85, 0xffff0000, v90
  v_lshlrev_b32 v84, 16, v90
  v_add_u32 v91, 162816, v91
  s_mov_b32 exec_lo, -1
  s_mov_b32 exec_hi, 0x00ffffff
  ds_write_b64 v91, v[82:83]
  ds_write_b64 v91, v[84:85] offset:448
  s_mov_b64 exec, -1
prep_cb:
  s_mul_i32 s66, s65, 23040
  s_and_b32 s67, s4, 1
  s_mul_i32 s67, s67, 1105920
  s_add_u32 s66, s66, s67
  s_add_u32 s66, s66, 65536
  buffer_load_dwordx4 v[128:131], v6, s[8:11], s66 offen sc1
  s_add_u32 s66, s66, 1024
  buffer_load_dwordx4 v[132:135], v6, s[8:11], s66 offen sc1
  s_add_u32 s66, s66, 1024
  buffer_load_dwordx4 v[136:139], v6, s[8:11], s66 offen sc1
  s_add_u32 s66, s66, 1024
  buffer_load_dwordx4 v[140:143], v6, s[8:11], s66 offen sc1
  s_add_u32 s66, s66, 1024
  buffer_load_dwordx4 v[144:147], v6, s[8:11], s66 offen sc1
  s_add_u32 s66, s66, 1024
  buffer_load_dwordx4 v[148:151], v6, s[8:11], s66 offen sc1
  s_add_u32 s66, s66, 1024
  buffer_load_dwordx4 v[152:155], v6, s[8:11], s66 offen sc1
  s_add_u32 s66, s66, 1024
  buffer_load_dwordx4 v[156:159], v6, s[8:11], s66 offen sc1
  s_add_u32 s66, s66, 1024
  buffer_load_dwordx4 v[160:163], v6, s[8:11], s66 offen sc1
  s_add_u32 s66, s66, 1024
  buffer_load_dwordx4 v[164:167], v6, s[8:11], s66 offen sc1
  s_add_u32 s66, s66, 1024
  buffer_load_dwordx4 v[168:171], v6, s[8:11], s66 offen sc1
  s_add_u32 s66, s66, 1024
  buffer_load_dwordx4 v[172:175], v6, s[8:11], s66 offen sc1
  s_add_u32 s66, s66, 1024
  buffer_load_dwordx4 v[176:179], v6, s[8:11], s66 offen sc1
  s_add_u32 s66, s66, 1024
  buffer_load_dwordx4 v[180:183], v6, s[8:11], s66 offen sc1
  s_add_u32 s66, s66, 1024
  buffer_load_dwordx4 v[184:187], v6, s[8:11], s66 offen sc1
  s_add_u32 s66, s66, 1024
  buffer_load_dwordx4 v[188:191], v6, s[8:11], s66 offen sc1
  s_add_u32 s66, s66, 1024
  buffer_load_dwordx4 v[192:195], v6, s[8:11], s66 offen sc1
  s_add_u32 s66, s66, 1024
  buffer_load_dwordx4 v[196:199], v6, s[8:11], s66 offen sc1
  s_add_u32 s66, s66, 1024
  buffer_load_dwordx4 v[200:203], v6, s[8:11], s66 offen sc1
  s_add_u32 s66, s66, 1024
  buffer_load_dwordx4 v[204:207], v6, s[8:11], s66 offen sc1
  s_add_u32 s66, s66, 1024
  buffer_load_dwordx4 v[208:211], v6, s[8:11], s66 offen sc1
  s_add_u32 s66, s66, 1024
  buffer_load_dwordx4 v[212:215], v6, s[8:11], s66 offen sc1
  s_add_u32 s66, s66, 1024
  buffer_load_dwordx4 v[216:219], v6, s[8:11], s66 offen sc1
  s_mov_b32 s79, -1
  s_branch mk_gemm
mk_roleA:
  s_and_b32 s4, s2, 7
  s_mul_i32 s4, s4, 20
  s_lshr_b32 s64, s2, 3
  s_add_u32 s4, s4, s64
  s_lshl_b32 s5, s4, 3
  s_add_u32 s64, s46, s5
  s_addc_u32 s65, s47, 0
  s_add_u32 s66, s48, s5
  s_addc_u32 s67, s49, 0
  s_load_dwordx2 s[68:69], s[64:65], 0
  s_load_dwordx2 s[6:7], s[66:67], 0
  s_lshl_b32 s70, s4, 2
  s_add_u32 s70, s70, s3
  s_lshl_b32 s70, s70, 8
  v_lshlrev_b32 v5, 2, v1
  v_add_u32 v5, s70, v5
  global_load_dword v56, v5, s[34:35] nt
  global_load_dword v57, v5, s[36:37] nt
  global_load_dword v58, v5, s[38:39] nt
  global_load_dword v59, v5, s[40:41] nt
  global_load_dword v60, v5, s[42:43] nt
  global_load_dword v61, v5, s[44:45] nt
  v_mov_b32 v64, 0
  v_mov_b32 v65, 0
  v_mov_b32 v66, 0
  v_mov_b32 v67, 0
  v_lshrrev_b32 v68, 5, v0
  v_mul_u32_u24 v68, 4608, v68
  v_and_b32 v69, 31, v0
  v_lshl_add_u32 v68, v69, 4, v68
  v_add_u32 v68, 145408, v68
  v_subrev_u32 v70, 128, v0
  v_lshrrev_b32 v71, 4, v70
  v_mul_u32_u24 v71, 8320, v71
  v_bfe_u32 v72, v70, 3, 1
  v_mul_u32_u24 v72, 4160, v72
  v_add_u32 v71, v71, v72
  v_and_b32 v72, 7, v70
  v_lshl_add_u32 v71, v72, 2, v71
  v_add_u32 v71, 116224, v71
  s_cmp_ge_u32 s3, 2
  s_cbranch_scc1 conv_z1
  ds_write_b128 v68, v[64:67]
conv_z1:
  s_cmp_lg_u32 s3, 2
  s_cbranch_scc1 conv_z2
  ds_write_b32 v71, v64
conv_z2:
  v_lshlrev_b32 v22, 2, v0
  v_sub_u32 v22, 2047, v22
  v_cvt_f32_i32 v23, v22
  v_cvt_pk_bf16_f32 v23, v23, v23
  v_and_b32 v23, 0xffff, v23
  v_subrev_u32 v23, 17024, v23
  v_cmp_gt_i32 vcc, 128, v22
  s_nop 1
  v_cndmask_b32 v23, v23, v22, vcc
  v_lshlrev_b32 v8, 1, v23
  v_add_u32 v8, 67584, v8
  v_lshlrev_b32 v22, 2, v0
  v_sub_u32 v22, 2046, v22
  v_cvt_f32_i32 v23, v22
  v_cvt_pk_bf16_f32 v23, v23, v23
  v_and_b32 v23, 0xffff, v23
  v_subrev_u32 v23, 17024, v23
  v_cmp_gt_i32 vcc, 128, v22
  s_nop 1
  v_cndmask_b32 v23, v23, v22, vcc
  v_lshlrev_b32 v9, 1, v23
  v_add_u32 v9, 67584, v9
  v_lshlrev_b32 v22, 2, v0
  v_sub_u32 v22, 2045, v22
  v_cvt_f32_i32 v23, v22
  v_cvt_pk_bf16_f32 v23, v23, v23
  v_and_b32 v23, 0xffff, v23
  v_subrev_u32 v23, 17024, v23
  v_cmp_gt_i32 vcc, 128, v22
  s_nop 1
  v_cndmask_b32 v23, v23, v22, vcc
  v_lshlrev_b32 v10, 1, v23
  v_add_u32 v10, 67584, v10
  v_lshlrev_b32 v22, 2, v0
  v_sub_u32 v22, 2044, v22
  v_cvt_f32_i32 v23, v22
  v_cvt_pk_bf16_f32 v23, v23, v23
  v_and_b32 v23, 0xffff, v23
  v_subrev_u32 v23, 17024, v23
  v_cmp_gt_i32 vcc, 128, v22
  s_nop 1
  v_cndmask_b32 v23, v23, v22, vcc
  v_lshlrev_b32 v11, 1, v23
  v_add_u32 v11, 67584, v11
  v_lshlrev_b32 v22, 2, v0
  v_sub_u32 v22, 2043, v22
  v_cvt_f32_i32 v23, v22
  v_cvt_pk_bf16_f32 v23, v23, v23
  v_and_b32 v23, 0xffff, v23
  v_subrev_u32 v23, 17024, v23
  v_cmp_gt_i32 vcc, 128, v22
  s_nop 1
  v_cndmask_b32 v23, v23, v22, vcc
  v_lshlrev_b32 v12, 1, v23
  v_add_u32 v12, 67584, v12
  v_lshlrev_b32 v22, 2, v0
  v_sub_u32 v22, 1023, v22
  v_cvt_f32_i32 v23, v22
  v_cvt_pk_bf16_f32 v23, v23, v23
  v_and_b32 v23, 0xffff, v23
  v_subrev_u32 v23, 17024, v23
  v_cmp_gt_i32 vcc, 128, v22
  s_nop 1
  v_cndmask_b32 v23, v23, v22, vcc
  v_lshlrev_b32 v13, 1, v23
  v_add_u32 v13, 67584, v13
  v_lshlrev_b32 v22, 2, v0
  v_sub_u32 v22, 1022, v22
  v_cvt_f32_i32 v23, v22
  v_cvt_pk_bf16_f32 v23, v23, v23
  v_and_b32 v23, 0xffff, v23
  v_subrev_u32 v23, 17024, v23
  v_cmp_gt_i32 vcc, 128, v22
  s_nop 1
  v_cndmask_b32 v23, v23, v22, vcc
  v_lshlrev_b32 v14, 1, v23
  v_add_u32 v14, 67584, v14
  v_lshlrev_b32 v22, 2, v0
  v_sub_u32 v22, 1021, v22
  v_cvt_f32_i32 v23, v22
  v_cvt_pk_bf16_f32 v23, v23, v23
  v_and_b32 v23, 0xffff, v23
  v_subrev_u32 v23, 17024, v23
  v_cmp_gt_i32 vcc, 128, v22
  s_nop 1
  v_cndmask_b32 v23, v23, v22, vcc
  v_lshlrev_b32 v15, 1, v23
  v_add_u32 v15, 67584, v15
  v_lshlrev_b32 v22, 2, v0
  v_sub_u32 v22, 1020, v22
  v_cvt_f32_i32 v23, v22
  v_cvt_pk_bf16_f32 v23, v23, v23
  v_and_b32 v23, 0xffff, v23
  v_subrev_u32 v23, 17024, v23
  v_cmp_gt_i32 vcc, 128, v22
  s_nop 1
  v_cndmask_b32 v23, v23, v22, vcc
  v_lshlrev_b32 v16, 1, v23
  v_add_u32 v16, 67584, v16
  v_lshlrev_b32 v22, 2, v0
  v_sub_u32 v22, 1019, v22
  v_cvt_f32_i32 v23, v22
  v_cvt_pk_bf16_f32 v23, v23, v23
  v_and_b32 v23, 0xffff, v23
  v_subrev_u32 v23, 17024, v23
  v_cmp_gt_i32 vcc, 128, v22
  s_nop 1
  v_cndmask_b32 v23, v23, v22, vcc
  v_cmp_gt_i32 vcc, 0, v22
  v_mov_b32 v21, 641
  s_nop 0
  v_cndmask_b32 v23, v23, v21, vcc
  v_lshlrev_b32 v17, 1, v23
  v_add_u32 v17, 67584, v17
  s_mul_i32 s70, s3, 1536
  s_add_u32 s70, s70, 67584
  v_lshlrev_b32 v18, 5, v2
  v_lshl_add_u32 v18, v3, 3, v18
  v_add_u32 v18, s70, v18
  v_lshlrev_b32 v19, 4, v2
  v_lshl_add_u32 v19, v3, 3, v19
  v_add_u32 v19, 512, v19
  v_lshlrev_b32 v20, 3, v2
  v_lshl_add_u32 v20, v3, 7, v20
  v_add_u32 v20, 512, v20
  v_cmp_gt_u32 vcc, 2, v3
  s_nop 1
  v_cndmask_b32 v19, v20, v19, vcc
  v_add_u32 v19, s70, v19
  v_lshlrev_b32 v20, 2, v2
  v_lshl_add_u32 v20, v3, 7, v20
  v_add_u32 v20, 1024, v20
  v_add_u32 v20, s70, v20
  s_mul_i32 s70, s3, 16896
  v_lshlrev_b32 v106, 3, v1
  v_add_u32 v106, s70, v106
  v_mul_u32_u24 v107, 528, v2
  v_lshl_add_u32 v107, v3, 4, v107
  v_add_u32 v107, s70, v107
  s_waitcnt lgkmcnt(0)
  s_cmp_ge_u32 s3, 2
  s_cselect_b32 s70, s69, s68
  s_and_b32 s71, s3, 1
  s_lshl_b32 s71, s71, 4
  s_lshr_b32 s70, s70, s71
  s_lshl_b32 s70, s70, 16
  v_mov_b32 v64, 0x3fb8aa3b
  v_mul_f32 v64, s70, v64
  v_exp_f32 v64, v64
  s_nop 0
  v_cvt_pk_bf16_f32 v64, v64, v64
  v_lshlrev_b32 v64, 16, v64
  v_mov_b32 v65, v64
  s_waitcnt vmcnt(0)
  v_mul_u32_u24 v6, 2560, v0
  s_add_u32 s76, s5, 0
  buffer_load_dwordx2 v[40:41], v6, s[16:19], s76 offen offset:0
  v_lshlrev_b32 v66, 16, v56
  v_and_b32 v67, 0xffff0000, v56
  v_lshlrev_b32 v68, 16, v57
  v_and_b32 v69, 0xffff0000, v57
  v_lshlrev_b32 v70, 16, v58
  v_and_b32 v71, 0xffff0000, v58
  v_lshlrev_b32 v72, 16, v59
  v_and_b32 v73, 0xffff0000, v59
  v_lshlrev_b32 v74, 16, v60
  v_and_b32 v75, 0xffff0000, v60
  v_lshlrev_b32 v76, 16, v61
  v_and_b32 v77, 0xffff0000, v61
  s_mov_b32 s70, 0x3fb8aa3b
  s_mov_b32 s72, 0x3e22f983
  v_pk_mul_f32 v[66:67], v[66:67], v[64:65]
  v_pk_mul_f32 v[68:69], v[68:69], v[64:65]
  v_pk_mul_f32 v[70:71], v[70:71], v[64:65]
  v_pk_mul_f32 v[72:73], v[72:73], v[64:65]
  v_pk_mul_f32 v[66:67], v[66:67], s[70:71] op_sel_hi:[1,0]
  v_pk_mul_f32 v[68:69], v[68:69], s[72:73] op_sel_hi:[1,0]
  v_pk_mul_f32 v[56:57], v[74:75], v[70:71]
  v_pk_mul_f32 v[58:59], v[74:75], v[72:73]
  v_pk_fma_f32 v[78:79], v[76:77], v[72:73], v[56:57] neg_lo:[1,0,0] neg_hi:[1,0,0]
  v_pk_fma_f32 v[80:81], v[76:77], v[70:71], v[58:59]
  s_mov_b32 s74, 0x3f800000
  v_pk_mul_f32 v[56:57], v[66:67], s[74:75] op_sel_hi:[1,0]
  v_pk_mul_f32 v[58:59], v[68:69], s[74:75] op_sel_hi:[1,0]
  v_exp_f32 v56, v56
  v_exp_f32 v57, v57
  v_fract_f32 v58, v58
  v_fract_f32 v59, v59
  v_cos_f32 v82, v58
  v_cos_f32 v83, v59
  v_sin_f32 v84, v58
  v_sin_f32 v85, v59
  s_nop 0
  v_pk_mul_f32 v[82:83], v[82:83], v[56:57]
  v_pk_mul_f32 v[84:85], v[84:85], v[56:57]
  s_mov_b32 s74, 0x41800000
  v_pk_mul_f32 v[56:57], v[66:67], s[74:75] op_sel_hi:[1,0]
  v_pk_mul_f32 v[58:59], v[68:69], s[74:75] op_sel_hi:[1,0]
  v_exp_f32 v56, v56
  v_exp_f32 v57, v57
  v_fract_f32 v58, v58
  v_fract_f32 v59, v59
  v_cos_f32 v86, v58
  v_cos_f32 v87, v59
  v_sin_f32 v88, v58
  v_sin_f32 v89, v59
  s_nop 0
  v_pk_mul_f32 v[86:87], v[86:87], v[56:57]
  v_pk_mul_f32 v[88:89], v[88:89], v[56:57]
  s_mov_b32 s74, 0x43800000
  v_pk_mul_f32 v[56:57], v[66:67], s[74:75] op_sel_hi:[1,0]
  v_pk_mul_f32 v[58:59], v[68:69], s[74:75] op_sel_hi:[1,0]
  v_exp_f32 v56, v56
  v_exp_f32 v57, v57
  v_fract_f32 v58, v58
  v_fract_f32 v59, v59
  v_cos_f32 v90, v58
  v_cos_f32 v91, v59
  v_sin_f32 v92, v58
  v_sin_f32 v93, v59
  s_nop 0
  v_pk_mul_f32 v[90:91], v[90:91], v[56:57]
  v_pk_mul_f32 v[92:93], v[92:93], v[56:57]
  v_pk_mul_f32 v[56:57], v[84:85], v[84:85]
  v_pk_add_f32 v[96:97], v[82:83], v[82:83]
  v_pk_fma_f32 v[94:95], v[82:83], v[82:83], v[56:57] neg_lo:[0,0,1] neg_hi:[0,0,1]
  v_pk_mul_f32 v[96:97], v[96:97], v[84:85]
  v_pk_mul_f32 v[56:57], v[96:97], v[96:97]
  v_pk_add_f32 v[100:101], v[94:95], v[94:95]
  v_pk_fma_f32 v[98:99], v[94:95], v[94:95], v[56:57] neg_lo:[0,0,1] neg_hi:[0,0,1]
  v_pk_mul_f32 v[100:101], v[100:101], v[96:97]
  v_pk_mul_f32 v[56:57], v[100:101], v[100:101]
  v_pk_add_f32 v[104:105], v[98:99], v[98:99]
  v_pk_fma_f32 v[102:103], v[98:99], v[98:99], v[56:57] neg_lo:[0,0,1] neg_hi:[0,0,1]
  v_pk_mul_f32 v[104:105], v[104:105], v[100:101]
  v_mov_b32 v116, 1.0
  v_mov_b32 v117, 1.0
  v_mov_b32 v118, 0
  v_mov_b32 v119, 0
  v_cvt_pk_bf16_f32 v108, v116, -v118
  v_cvt_pk_bf16_f32 v109, v117, -v119
  ds_write_b64 v106, v[108:109] offset:0
  v_pk_mov_b32 v[116:117], v[86:87], v[86:87] op_sel:[0,1]
  v_pk_mov_b32 v[118:119], v[88:89], v[88:89] op_sel:[0,1]
  v_pk_mov_b32 v[120:121], v[78:79], v[78:79] op_sel:[0,1]
  v_pk_mov_b32 v[122:123], v[80:81], v[80:81] op_sel:[0,1]
  v_cvt_pk_bf16_f32 v110, v116, -v118
  v_cvt_pk_bf16_f32 v111, v117, -v119
  ds_write_b64 v106, v[110:111] offset:528
  v_cvt_pk_bf16_f32 v112, v120, v122
  v_cvt_pk_bf16_f32 v113, v121, v123
  ds_write_b64 v106, v[112:113] offset:8448
  v_pk_mul_f32 v[56:57], v[120:121], v[82:83]
  v_pk_mul_f32 v[58:59], v[120:121], v[84:85]
  v_pk_fma_f32 v[120:121], v[122:123], v[84:85], v[56:57] neg_lo:[1,0,0] neg_hi:[1,0,0]
  v_pk_fma_f32 v[122:123], v[122:123], v[82:83], v[58:59]
  v_cvt_pk_bf16_f32 v114, v120, v122
  v_cvt_pk_bf16_f32 v115, v121, v123
  ds_write_b64 v106, v[114:115] offset:8976
  s_add_u32 s76, s5, 0
  buffer_load_dwordx2 v[42:43], v6, s[16:19], s76 offen offset:1280
  v_pk_mul_f32 v[56:57], v[120:121], v[82:83]
  v_pk_mul_f32 v[58:59], v[120:121], v[84:85]
  v_pk_fma_f32 v[120:121], v[122:123], v[84:85], v[56:57] neg_lo:[1,0,0] neg_hi:[1,0,0]
  v_pk_fma_f32 v[122:123], v[122:123], v[82:83], v[58:59]
  v_cvt_pk_bf16_f32 v108, v120, v122
  v_cvt_pk_bf16_f32 v109, v121, v123
  v_pk_mul_f32 v[60:61], v[116:117], v[86:87]
  v_pk_mul_f32 v[62:63], v[116:117], v[88:89]
  v_pk_fma_f32 v[116:117], v[118:119], v[88:89], v[60:61] neg_lo:[1,0,0] neg_hi:[1,0,0]
  v_pk_fma_f32 v[118:119], v[118:119], v[86:87], v[62:63]
  ds_write_b64 v106, v[108:109] offset:9504
  v_cvt_pk_bf16_f32 v110, v116, -v118
  v_cvt_pk_bf16_f32 v111, v117, -v119
  v_pk_mul_f32 v[56:57], v[120:121], v[82:83]
  v_pk_mul_f32 v[58:59], v[120:121], v[84:85]
  v_pk_fma_f32 v[120:121], v[122:123], v[84:85], v[56:57] neg_lo:[1,0,0] neg_hi:[1,0,0]
  v_pk_fma_f32 v[122:123], v[122:123], v[82:83], v[58:59]
  ds_write_b64 v106, v[110:111] offset:1056
  v_cvt_pk_bf16_f32 v112, v120, v122
  v_cvt_pk_bf16_f32 v113, v121, v123
  v_pk_mul_f32 v[60:61], v[116:117], v[86:87]
  v_pk_mul_f32 v[62:63], v[116:117], v[88:89]
  v_pk_fma_f32 v[116:117], v[118:119], v[88:89], v[60:61] neg_lo:[1,0,0] neg_hi:[1,0,0]
  v_pk_fma_f32 v[118:119], v[118:119], v[86:87], v[62:63]
  ds_write_b64 v106, v[112:113] offset:10032
  v_cvt_pk_bf16_f32 v114, v116, -v118
  v_cvt_pk_bf16_f32 v115, v117, -v119
  v_pk_mul_f32 v[56:57], v[120:121], v[82:83]
  v_pk_mul_f32 v[58:59], v[120:121], v[84:85]
  v_pk_fma_f32 v[120:121], v[122:123], v[84:85], v[56:57] neg_lo:[1,0,0] neg_hi:[1,0,0]
  v_pk_fma_f32 v[122:123], v[122:123], v[82:83], v[58:59]
  ds_write_b64 v106, v[114:115] offset:1584
  v_cvt_pk_bf16_f32 v108, v120, v122
  v_cvt_pk_bf16_f32 v109, v121, v123
  v_pk_mul_f32 v[60:61], v[116:117], v[86:87]
  v_pk_mul_f32 v[62:63], v[116:117], v[88:89]
  v_pk_fma_f32 v[116:117], v[118:119], v[88:89], v[60:61] neg_lo:[1,0,0] neg_hi:[1,0,0]
  v_pk_fma_f32 v[118:119], v[118:119], v[86:87], v[62:63]
  ds_write_b64 v106, v[108:109] offset:10560
  v_cvt_pk_bf16_f32 v110, v116, -v118
  v_cvt_pk_bf16_f32 v111, v117, -v119
  v_pk_mul_f32 v[56:57], v[120:121], v[82:83]
  v_pk_mul_f32 v[58:59], v[120:121], v[84:85]
  v_pk_fma_f32 v[120:121], v[122:123], v[84:85], v[56:57] neg_lo:[1,0,0] neg_hi:[1,0,0]
  v_pk_fma_f32 v[122:123], v[122:123], v[82:83], v[58:59]
  ds_write_b64 v106, v[110:111] offset:2112
  v_cvt_pk_bf16_f32 v112, v120, v122
  v_cvt_pk_bf16_f32 v113, v121, v123
  v_pk_mul_f32 v[60:61], v[116:117], v[86:87]
  v_pk_mul_f32 v[62:63], v[116:117], v[88:89]
  v_pk_fma_f32 v[116:117], v[118:119], v[88:89], v[60:61] neg_lo:[1,0,0] neg_hi:[1,0,0]
  v_pk_fma_f32 v[118:119], v[118:119], v[86:87], v[62:63]
  ds_write_b64 v106, v[112:113] offset:11088
  v_cvt_pk_bf16_f32 v114, v116, -v118
  v_cvt_pk_bf16_f32 v115, v117, -v119
  v_pk_mul_f32 v[56:57], v[120:121], v[82:83]
  v_pk_mul_f32 v[58:59], v[120:121], v[84:85]
  v_pk_fma_f32 v[120:121], v[122:123], v[84:85], v[56:57] neg_lo:[1,0,0] neg_hi:[1,0,0]
  v_pk_fma_f32 v[122:123], v[122:123], v[82:83], v[58:59]
  ds_write_b64 v106, v[114:115] offset:2640
  v_cvt_pk_bf16_f32 v108, v120, v122
  v_cvt_pk_bf16_f32 v109, v121, v123
  v_pk_mul_f32 v[60:61], v[116:117], v[86:87]
  v_pk_mul_f32 v[62:63], v[116:117], v[88:89]
  v_pk_fma_f32 v[116:117], v[118:119], v[88:89], v[60:61] neg_lo:[1,0,0] neg_hi:[1,0,0]
  v_pk_fma_f32 v[118:119], v[118:119], v[86:87], v[62:63]
  ds_write_b64 v106, v[108:109] offset:11616
  v_cvt_pk_bf16_f32 v110, v116, -v118
  v_cvt_pk_bf16_f32 v111, v117, -v119
  s_add_u32 s76, s5, 655360
  buffer_load_dwordx2 v[44:45], v6, s[16:19], s76 offen offset:0
  v_pk_mul_f32 v[56:57], v[120:121], v[82:83]
  v_pk_mul_f32 v[58:59], v[120:121], v[84:85]
  v_pk_fma_f32 v[120:121], v[122:123], v[84:85], v[56:57] neg_lo:[1,0,0] neg_hi:[1,0,0]
  v_pk_fma_f32 v[122:123], v[122:123], v[82:83], v[58:59]
  ds_write_b64 v106, v[110:111] offset:3168
  v_cvt_pk_bf16_f32 v112, v120, v122
  v_cvt_pk_bf16_f32 v113, v121, v123
  v_pk_mul_f32 v[60:61], v[116:117], v[86:87]
  v_pk_mul_f32 v[62:63], v[116:117], v[88:89]
  v_pk_fma_f32 v[116:117], v[118:119], v[88:89], v[60:61] neg_lo:[1,0,0] neg_hi:[1,0,0]
  v_pk_fma_f32 v[118:119], v[118:119], v[86:87], v[62:63]
  ds_write_b64 v106, v[112:113] offset:12144
  v_cvt_pk_bf16_f32 v114, v116, -v118
  v_cvt_pk_bf16_f32 v115, v117, -v119
  v_pk_mul_f32 v[56:57], v[120:121], v[82:83]
  v_pk_mul_f32 v[58:59], v[120:121], v[84:85]
  v_pk_fma_f32 v[120:121], v[122:123], v[84:85], v[56:57] neg_lo:[1,0,0] neg_hi:[1,0,0]
  v_pk_fma_f32 v[122:123], v[122:123], v[82:83], v[58:59]
  ds_write_b64 v106, v[114:115] offset:3696
  v_cvt_pk_bf16_f32 v108, v120, v122
  v_cvt_pk_bf16_f32 v109, v121, v123
  v_pk_mul_f32 v[60:61], v[116:117], v[86:87]
  v_pk_mul_f32 v[62:63], v[116:117], v[88:89]
  v_pk_fma_f32 v[116:117], v[118:119], v[88:89], v[60:61] neg_lo:[1,0,0] neg_hi:[1,0,0]
  v_pk_fma_f32 v[118:119], v[118:119], v[86:87], v[62:63]
  ds_write_b64 v106, v[108:109] offset:12672
  v_cvt_pk_bf16_f32 v110, v116, -v118
  v_cvt_pk_bf16_f32 v111, v117, -v119
  v_pk_mul_f32 v[56:57], v[120:121], v[82:83]
  v_pk_mul_f32 v[58:59], v[120:121], v[84:85]
  v_pk_fma_f32 v[120:121], v[122:123], v[84:85], v[56:57] neg_lo:[1,0,0] neg_hi:[1,0,0]
  v_pk_fma_f32 v[122:123], v[122:123], v[82:83], v[58:59]
  ds_write_b64 v106, v[110:111] offset:4224
  v_cvt_pk_bf16_f32 v112, v120, v122
  v_cvt_pk_bf16_f32 v113, v121, v123
  v_pk_mul_f32 v[60:61], v[116:117], v[86:87]
  v_pk_mul_f32 v[62:63], v[116:117], v[88:89]
  v_pk_fma_f32 v[116:117], v[118:119], v[88:89], v[60:61] neg_lo:[1,0,0] neg_hi:[1,0,0]
  v_pk_fma_f32 v[118:119], v[118:119], v[86:87], v[62:63]
  ds_write_b64 v106, v[112:113] offset:13200
  v_cvt_pk_bf16_f32 v114, v116, -v118
  v_cvt_pk_bf16_f32 v115, v117, -v119
  v_pk_mul_f32 v[56:57], v[120:121], v[82:83]
  v_pk_mul_f32 v[58:59], v[120:121], v[84:85]
  v_pk_fma_f32 v[120:121], v[122:123], v[84:85], v[56:57] neg_lo:[1,0,0] neg_hi:[1,0,0]
  v_pk_fma_f32 v[122:123], v[122:123], v[82:83], v[58:59]
  ds_write_b64 v106, v[114:115] offset:4752
  v_cvt_pk_bf16_f32 v108, v120, v122
  v_cvt_pk_bf16_f32 v109, v121, v123
  v_pk_mul_f32 v[60:61], v[116:117], v[86:87]
  v_pk_mul_f32 v[62:63], v[116:117], v[88:89]
  v_pk_fma_f32 v[116:117], v[118:119], v[88:89], v[60:61] neg_lo:[1,0,0] neg_hi:[1,0,0]
  v_pk_fma_f32 v[118:119], v[118:119], v[86:87], v[62:63]
  ds_write_b64 v106, v[108:109] offset:13728
  v_cvt_pk_bf16_f32 v110, v116, -v118
  v_cvt_pk_bf16_f32 v111, v117, -v119
  v_pk_mul_f32 v[56:57], v[120:121], v[82:83]
  v_pk_mul_f32 v[58:59], v[120:121], v[84:85]
  v_pk_fma_f32 v[120:121], v[122:123], v[84:85], v[56:57] neg_lo:[1,0,0] neg_hi:[1,0,0]
  v_pk_fma_f32 v[122:123], v[122:123], v[82:83], v[58:59]
  ds_write_b64 v106, v[110:111] offset:5280
  v_cvt_pk_bf16_f32 v112, v120, v122
  v_cvt_pk_bf16_f32 v113, v121, v123
  v_pk_mul_f32 v[60:61], v[116:117], v[86:87]
  v_pk_mul_f32 v[62:63], v[116:117], v[88:89]
  v_pk_fma_f32 v[116:117], v[118:119], v[88:89], v[60:61] neg_lo:[1,0,0] neg_hi:[1,0,0]
  v_pk_fma_f32 v[118:119], v[118:119], v[86:87], v[62:63]
  ds_write_b64 v106, v[112:113] offset:14256
  v_cvt_pk_bf16_f32 v114, v116, -v118
  v_cvt_pk_bf16_f32 v115, v117, -v119
  s_add_u32 s76, s5, 655360
  buffer_load_dwordx2 v[46:47], v6, s[16:19], s76 offen offset:1280
  v_pk_mul_f32 v[56:57], v[120:121], v[82:83]
  v_pk_mul_f32 v[58:59], v[120:121], v[84:85]
  v_pk_fma_f32 v[120:121], v[122:123], v[84:85], v[56:57] neg_lo:[1,0,0] neg_hi:[1,0,0]
  v_pk_fma_f32 v[122:123], v[122:123], v[82:83], v[58:59]
  ds_write_b64 v106, v[114:115] offset:5808
  v_cvt_pk_bf16_f32 v108, v120, v122
  v_cvt_pk_bf16_f32 v109, v121, v123
  v_pk_mul_f32 v[60:61], v[116:117], v[86:87]
  v_pk_mul_f32 v[62:63], v[116:117], v[88:89]
  v_pk_fma_f32 v[116:117], v[118:119], v[88:89], v[60:61] neg_lo:[1,0,0] neg_hi:[1,0,0]
  v_pk_fma_f32 v[118:119], v[118:119], v[86:87], v[62:63]
  ds_write_b64 v106, v[108:109] offset:14784
  v_cvt_pk_bf16_f32 v110, v116, -v118
  v_cvt_pk_bf16_f32 v111, v117, -v119
  v_pk_mul_f32 v[56:57], v[120:121], v[82:83]
  v_pk_mul_f32 v[58:59], v[120:121], v[84:85]
  v_pk_fma_f32 v[120:121], v[122:123], v[84:85], v[56:57] neg_lo:[1,0,0] neg_hi:[1,0,0]
  v_pk_fma_f32 v[122:123], v[122:123], v[82:83], v[58:59]
  ds_write_b64 v106, v[110:111] offset:6336
  v_cvt_pk_bf16_f32 v112, v120, v122
  v_cvt_pk_bf16_f32 v113, v121, v123
  v_pk_mul_f32 v[60:61], v[116:117], v[86:87]
  v_pk_mul_f32 v[62:63], v[116:117], v[88:89]
  v_pk_fma_f32 v[116:117], v[118:119], v[88:89], v[60:61] neg_lo:[1,0,0] neg_hi:[1,0,0]
  v_pk_fma_f32 v[118:119], v[118:119], v[86:87], v[62:63]
  ds_write_b64 v106, v[112:113] offset:15312
  v_cvt_pk_bf16_f32 v114, v116, -v118
  v_cvt_pk_bf16_f32 v115, v117, -v119
  v_pk_mul_f32 v[56:57], v[120:121], v[82:83]
  v_pk_mul_f32 v[58:59], v[120:121], v[84:85]
  v_pk_fma_f32 v[120:121], v[122:123], v[84:85], v[56:57] neg_lo:[1,0,0] neg_hi:[1,0,0]
  v_pk_fma_f32 v[122:123], v[122:123], v[82:83], v[58:59]
  ds_write_b64 v106, v[114:115] offset:6864
  v_cvt_pk_bf16_f32 v108, v120, v122
  v_cvt_pk_bf16_f32 v109, v121, v123
  v_pk_mul_f32 v[60:61], v[116:117], v[86:87]
  v_pk_mul_f32 v[62:63], v[116:117], v[88:89]
  v_pk_fma_f32 v[116:117], v[118:119], v[88:89], v[60:61] neg_lo:[1,0,0] neg_hi:[1,0,0]
  v_pk_fma_f32 v[118:119], v[118:119], v[86:87], v[62:63]
  ds_write_b64 v106, v[108:109] offset:15840
  v_cvt_pk_bf16_f32 v110, v116, -v118
  v_cvt_pk_bf16_f32 v111, v117, -v119
  v_pk_mul_f32 v[56:57], v[120:121], v[82:83]
  v_pk_mul_f32 v[58:59], v[120:121], v[84:85]
  v_pk_fma_f32 v[120:121], v[122:123], v[84:85], v[56:57] neg_lo:[1,0,0] neg_hi:[1,0,0]
  v_pk_fma_f32 v[122:123], v[122:123], v[82:83], v[58:59]
  ds_write_b64 v106, v[110:111] offset:7392
  v_cvt_pk_bf16_f32 v112, v120, v122
  v_cvt_pk_bf16_f32 v113, v121, v123
  v_pk_mul_f32 v[60:61], v[116:117], v[86:87]
  v_pk_mul_f32 v[62:63], v[116:117], v[88:89]
  v_pk_fma_f32 v[116:117], v[118:119], v[88:89], v[60:61] neg_lo:[1,0,0] neg_hi:[1,0,0]
  v_pk_fma_f32 v[118:119], v[118:119], v[86:87], v[62:63]
  ds_write_b64 v106, v[112:113] offset:16368
  v_cvt_pk_bf16_f32 v114, v116, -v118
  v_cvt_pk_bf16_f32 v115, v117, -v119
  ds_write_b64 v106, v[114:115] offset:7920
  ds_read_b128 v[128:131], v107 offset:0
  ds_read_b128 v[132:135], v107 offset:64
  ds_read_b128 v[136:139], v107 offset:128
  ds_read_b128 v[140:143], v107 offset:192
  ds_read_b128 v[144:147], v107 offset:256
  ds_read_b128 v[148:151], v107 offset:320
  ds_read_b128 v[152:155], v107 offset:384
  ds_read_b128 v[156:159], v107 offset:448
  ds_read_b128 v[160:163], v107 offset:8448
  ds_read_b128 v[164:167], v107 offset:8512
  ds_read_b128 v[168:171], v107 offset:8576
  ds_read_b128 v[172:175], v107 offset:8640
  ds_read_b128 v[176:179], v107 offset:8704
  ds_read_b128 v[180:183], v107 offset:8768
  ds_read_b128 v[184:187], v107 offset:8832
  ds_read_b128 v[188:191], v107 offset:8896
  s_add_u32 s76, s5, 1310720
  buffer_load_dwordx2 v[48:49], v6, s[16:19], s76 offen offset:0
  v_pk_mul_f32 v[56:57], v[78:79], v[90:91]
  v_pk_mul_f32 v[58:59], v[78:79], v[92:93]
  v_pk_fma_f32 v[116:117], v[80:81], v[92:93], v[56:57] neg_lo:[1,0,0] neg_hi:[1,0,0]
  v_pk_fma_f32 v[118:119], v[80:81], v[90:91], v[58:59]
  v_pk_mov_b32 v[120:121], v[116:117], v[116:117] op_sel:[0,1]
  v_pk_mov_b32 v[122:123], v[118:119], v[118:119] op_sel:[0,1]
  v_cvt_pk_bf16_f32 v108, v120, v122
  v_cvt_pk_bf16_f32 v109, v121, v123
  ds_write_b64 v106, v[108:109] offset:0
  v_pk_mul_f32 v[56:57], v[120:121], v[94:95]
  v_pk_mul_f32 v[58:59], v[120:121], v[96:97]
  v_pk_fma_f32 v[120:121], v[122:123], v[96:97], v[56:57] neg_lo:[1,0,0] neg_hi:[1,0,0]
  v_pk_fma_f32 v[122:123], v[122:123], v[94:95], v[58:59]
  v_cvt_pk_bf16_f32 v110, v120, v122
  v_cvt_pk_bf16_f32 v111, v121, v123
  ds_write_b64 v106, v[110:111] offset:528
  v_pk_mul_f32 v[56:57], v[120:121], v[94:95]
  v_pk_mul_f32 v[58:59], v[120:121], v[96:97]
  v_pk_fma_f32 v[120:121], v[122:123], v[96:97], v[56:57] neg_lo:[1,0,0] neg_hi:[1,0,0]
  v_pk_fma_f32 v[122:123], v[122:123], v[94:95], v[58:59]
  v_cvt_pk_bf16_f32 v112, v120, v122
  v_cvt_pk_bf16_f32 v113, v121, v123
  ds_write_b64 v106, v[112:113] offset:1056
  v_pk_mul_f32 v[56:57], v[120:121], v[94:95]
  v_pk_mul_f32 v[58:59], v[120:121], v[96:97]
  v_pk_fma_f32 v[120:121], v[122:123], v[96:97], v[56:57] neg_lo:[1,0,0] neg_hi:[1,0,0]
  v_pk_fma_f32 v[122:123], v[122:123], v[94:95], v[58:59]
  v_cvt_pk_bf16_f32 v114, v120, v122
  v_cvt_pk_bf16_f32 v115, v121, v123
  ds_write_b64 v106, v[114:115] offset:1584
  v_pk_mul_f32 v[56:57], v[120:121], v[94:95]
  v_pk_mul_f32 v[58:59], v[120:121], v[96:97]
  v_pk_fma_f32 v[120:121], v[122:123], v[96:97], v[56:57] neg_lo:[1,0,0] neg_hi:[1,0,0]
  v_pk_fma_f32 v[122:123], v[122:123], v[94:95], v[58:59]
  v_cvt_pk_bf16_f32 v108, v120, v122
  v_cvt_pk_bf16_f32 v109, v121, v123
  ds_write_b64 v106, v[108:109] offset:2112
  v_pk_mul_f32 v[56:57], v[120:121], v[94:95]
  v_pk_mul_f32 v[58:59], v[120:121], v[96:97]
  v_pk_fma_f32 v[120:121], v[122:123], v[96:97], v[56:57] neg_lo:[1,0,0] neg_hi:[1,0,0]
  v_pk_fma_f32 v[122:123], v[122:123], v[94:95], v[58:59]
  v_cvt_pk_bf16_f32 v110, v120, v122
  v_cvt_pk_bf16_f32 v111, v121, v123
  ds_write_b64 v106, v[110:111] offset:2640
  v_pk_mul_f32 v[56:57], v[120:121], v[94:95]
  v_pk_mul_f32 v[58:59], v[120:121], v[96:97]
  v_pk_fma_f32 v[120:121], v[122:123], v[96:97], v[56:57] neg_lo:[1,0,0] neg_hi:[1,0,0]
  v_pk_fma_f32 v[122:123], v[122:123], v[94:95], v[58:59]
  v_cvt_pk_bf16_f32 v112, v120, v122
  v_cvt_pk_bf16_f32 v113, v121, v123
  ds_write_b64 v106, v[112:113] offset:3168
  v_pk_mul_f32 v[56:57], v[120:121], v[94:95]
  v_pk_mul_f32 v[58:59], v[120:121], v[96:97]
  v_pk_fma_f32 v[120:121], v[122:123], v[96:97], v[56:57] neg_lo:[1,0,0] neg_hi:[1,0,0]
  v_pk_fma_f32 v[122:123], v[122:123], v[94:95], v[58:59]
  v_cvt_pk_bf16_f32 v114, v120, v122
  v_cvt_pk_bf16_f32 v115, v121, v123
  ds_write_b64 v106, v[114:115] offset:3696
  s_add_u32 s76, s5, 1310720
  buffer_load_dwordx2 v[50:51], v6, s[16:19], s76 offen offset:1280
  v_pk_mul_f32 v[60:61], v[116:117], v[90:91]
  v_pk_mul_f32 v[62:63], v[116:117], v[92:93]
  v_pk_fma_f32 v[116:117], v[118:119], v[92:93], v[60:61] neg_lo:[1,0,0] neg_hi:[1,0,0]
  v_pk_fma_f32 v[118:119], v[118:119], v[90:91], v[62:63]
  v_pk_mov_b32 v[120:121], v[116:117], v[116:117] op_sel:[0,1]
  v_pk_mov_b32 v[122:123], v[118:119], v[118:119] op_sel:[0,1]
  v_cvt_pk_bf16_f32 v108, v120, v122
  v_cvt_pk_bf16_f32 v109, v121, v123
  ds_write_b64 v106, v[108:109] offset:4224
  v_pk_mul_f32 v[56:57], v[120:121], v[98:99]
  v_pk_mul_f32 v[58:59], v[120:121], v[100:101]
  v_pk_fma_f32 v[120:121], v[122:123], v[100:101], v[56:57] neg_lo:[1,0,0] neg_hi:[1,0,0]
  v_pk_fma_f32 v[122:123], v[122:123], v[98:99], v[58:59]
  v_cvt_pk_bf16_f32 v110, v120, v122
  v_cvt_pk_bf16_f32 v111, v121, v123
  ds_write_b64 v106, v[110:111] offset:4752
  v_pk_mul_f32 v[56:57], v[120:121], v[98:99]
  v_pk_mul_f32 v[58:59], v[120:121], v[100:101]
  v_pk_fma_f32 v[120:121], v[122:123], v[100:101], v[56:57] neg_lo:[1,0,0] neg_hi:[1,0,0]
  v_pk_fma_f32 v[122:123], v[122:123], v[98:99], v[58:59]
  v_cvt_pk_bf16_f32 v112, v120, v122
  v_cvt_pk_bf16_f32 v113, v121, v123
  ds_write_b64 v106, v[112:113] offset:5280
  v_pk_mul_f32 v[56:57], v[120:121], v[98:99]
  v_pk_mul_f32 v[58:59], v[120:121], v[100:101]
  v_pk_fma_f32 v[120:121], v[122:123], v[100:101], v[56:57] neg_lo:[1,0,0] neg_hi:[1,0,0]
  v_pk_fma_f32 v[122:123], v[122:123], v[98:99], v[58:59]
  v_cvt_pk_bf16_f32 v114, v120, v122
  v_cvt_pk_bf16_f32 v115, v121, v123
  ds_write_b64 v106, v[114:115] offset:5808
  v_pk_mul_f32 v[60:61], v[116:117], v[90:91]
  v_pk_mul_f32 v[62:63], v[116:117], v[92:93]
  v_pk_fma_f32 v[116:117], v[118:119], v[92:93], v[60:61] neg_lo:[1,0,0] neg_hi:[1,0,0]
  v_pk_fma_f32 v[118:119], v[118:119], v[90:91], v[62:63]
  v_pk_mov_b32 v[120:121], v[116:117], v[116:117] op_sel:[0,1]
  v_pk_mov_b32 v[122:123], v[118:119], v[118:119] op_sel:[0,1]
  v_cvt_pk_bf16_f32 v108, v120, v122
  v_cvt_pk_bf16_f32 v109, v121, v123
  ds_write_b64 v106, v[108:109] offset:6336
  v_pk_mul_f32 v[56:57], v[120:121], v[98:99]
  v_pk_mul_f32 v[58:59], v[120:121], v[100:101]
  v_pk_fma_f32 v[120:121], v[122:123], v[100:101], v[56:57] neg_lo:[1,0,0] neg_hi:[1,0,0]
  v_pk_fma_f32 v[122:123], v[122:123], v[98:99], v[58:59]
  v_cvt_pk_bf16_f32 v110, v120, v122
  v_cvt_pk_bf16_f32 v111, v121, v123
  ds_write_b64 v106, v[110:111] offset:6864
  v_pk_mul_f32 v[56:57], v[120:121], v[98:99]
  v_pk_mul_f32 v[58:59], v[120:121], v[100:101]
  v_pk_fma_f32 v[120:121], v[122:123], v[100:101], v[56:57] neg_lo:[1,0,0] neg_hi:[1,0,0]
  v_pk_fma_f32 v[122:123], v[122:123], v[98:99], v[58:59]
  v_cvt_pk_bf16_f32 v112, v120, v122
  v_cvt_pk_bf16_f32 v113, v121, v123
  ds_write_b64 v106, v[112:113] offset:7392
  v_pk_mul_f32 v[56:57], v[120:121], v[98:99]
  v_pk_mul_f32 v[58:59], v[120:121], v[100:101]
  v_pk_fma_f32 v[120:121], v[122:123], v[100:101], v[56:57] neg_lo:[1,0,0] neg_hi:[1,0,0]
  v_pk_fma_f32 v[122:123], v[122:123], v[98:99], v[58:59]
  v_cvt_pk_bf16_f32 v114, v120, v122
  v_cvt_pk_bf16_f32 v115, v121, v123
  ds_write_b64 v106, v[114:115] offset:7920
  s_add_u32 s76, s5, 1966080
  buffer_load_dwordx2 v[52:53], v6, s[16:19], s76 offen offset:0
  v_pk_mul_f32 v[60:61], v[116:117], v[90:91]
  v_pk_mul_f32 v[62:63], v[116:117], v[92:93]
  v_pk_fma_f32 v[116:117], v[118:119], v[92:93], v[60:61] neg_lo:[1,0,0] neg_hi:[1,0,0]
  v_pk_fma_f32 v[118:119], v[118:119], v[90:91], v[62:63]
  v_cvt_pk_bf16_f32 v108, v116, v118
  v_cvt_pk_bf16_f32 v109, v117, v119
  ds_write_b64 v106, v[108:109] offset:8448
  v_pk_mul_f32 v[56:57], v[116:117], v[102:103]
  v_pk_mul_f32 v[58:59], v[116:117], v[104:105]
  v_pk_fma_f32 v[120:121], v[118:119], v[104:105], v[56:57] neg_lo:[1,0,0] neg_hi:[1,0,0]
  v_pk_fma_f32 v[122:123], v[118:119], v[102:103], v[58:59]
  v_cvt_pk_bf16_f32 v110, v120, v122
  v_cvt_pk_bf16_f32 v111, v121, v123
  ds_write_b64 v106, v[110:111] offset:8976
  v_pk_mul_f32 v[60:61], v[116:117], v[90:91]
  v_pk_mul_f32 v[62:63], v[116:117], v[92:93]
  v_pk_fma_f32 v[116:117], v[118:119], v[92:93], v[60:61] neg_lo:[1,0,0] neg_hi:[1,0,0]
  v_pk_fma_f32 v[118:119], v[118:119], v[90:91], v[62:63]
  v_cvt_pk_bf16_f32 v112, v116, v118
  v_cvt_pk_bf16_f32 v113, v117, v119
  ds_write_b64 v106, v[112:113] offset:9504
  v_pk_mul_f32 v[56:57], v[116:117], v[102:103]
  v_pk_mul_f32 v[58:59], v[116:117], v[104:105]
  v_pk_fma_f32 v[120:121], v[118:119], v[104:105], v[56:57] neg_lo:[1,0,0] neg_hi:[1,0,0]
  v_pk_fma_f32 v[122:123], v[118:119], v[102:103], v[58:59]
  v_cvt_pk_bf16_f32 v114, v120, v122
  v_cvt_pk_bf16_f32 v115, v121, v123
  ds_write_b64 v106, v[114:115] offset:10032
  v_pk_mul_f32 v[60:61], v[116:117], v[90:91]
  v_pk_mul_f32 v[62:63], v[116:117], v[92:93]
  v_pk_fma_f32 v[116:117], v[118:119], v[92:93], v[60:61] neg_lo:[1,0,0] neg_hi:[1,0,0]
  v_pk_fma_f32 v[118:119], v[118:119], v[90:91], v[62:63]
  v_cvt_pk_bf16_f32 v108, v116, v118
  v_cvt_pk_bf16_f32 v109, v117, v119
  ds_write_b64 v106, v[108:109] offset:10560
  v_pk_mul_f32 v[56:57], v[116:117], v[102:103]
  v_pk_mul_f32 v[58:59], v[116:117], v[104:105]
  v_pk_fma_f32 v[120:121], v[118:119], v[104:105], v[56:57] neg_lo:[1,0,0] neg_hi:[1,0,0]
  v_pk_fma_f32 v[122:123], v[118:119], v[102:103], v[58:59]
  v_cvt_pk_bf16_f32 v110, v120, v122
  v_cvt_pk_bf16_f32 v111, v121, v123
  ds_write_b64 v106, v[110:111] offset:11088
  v_pk_mul_f32 v[60:61], v[116:117], v[90:91]
  v_pk_mul_f32 v[62:63], v[116:117], v[92:93]
  v_pk_fma_f32 v[116:117], v[118:119], v[92:93], v[60:61] neg_lo:[1,0,0] neg_hi:[1,0,0]
  v_pk_fma_f32 v[118:119], v[118:119], v[90:91], v[62:63]
  v_cvt_pk_bf16_f32 v112, v116, v118
  v_cvt_pk_bf16_f32 v113, v117, v119
  ds_write_b64 v106, v[112:113] offset:11616
  v_pk_mul_f32 v[56:57], v[116:117], v[102:103]
  v_pk_mul_f32 v[58:59], v[116:117], v[104:105]
  v_pk_fma_f32 v[120:121], v[118:119], v[104:105], v[56:57] neg_lo:[1,0,0] neg_hi:[1,0,0]
  v_pk_fma_f32 v[122:123], v[118:119], v[102:103], v[58:59]
  v_cvt_pk_bf16_f32 v114, v120, v122
  v_cvt_pk_bf16_f32 v115, v121, v123
  ds_write_b64 v106, v[114:115] offset:12144
  v_pk_mul_f32 v[60:61], v[116:117], v[90:91]
  v_pk_mul_f32 v[62:63], v[116:117], v[92:93]
  v_pk_fma_f32 v[116:117], v[118:119], v[92:93], v[60:61] neg_lo:[1,0,0] neg_hi:[1,0,0]
  v_pk_fma_f32 v[118:119], v[118:119], v[90:91], v[62:63]
  v_cvt_pk_bf16_f32 v108, v116, v118
  v_cvt_pk_bf16_f32 v109, v117, v119
  ds_write_b64 v106, v[108:109] offset:12672
  s_add_u32 s76, s5, 1966080
  buffer_load_dwordx2 v[54:55], v6, s[16:19], s76 offen offset:1280
  v_mov_b32 v56, 0
  v_mov_b32 v57, 0
  ds_write_b64 v106, v[56:57] offset:13200
  ds_write_b64 v106, v[56:57] offset:13728
  ds_write_b64 v106, v[56:57] offset:14256
  ds_write_b64 v106, v[56:57] offset:14784
  ds_write_b64 v106, v[56:57] offset:15312
  ds_write_b64 v106, v[56:57] offset:15840
  ds_write_b64 v106, v[56:57] offset:16368
  s_waitcnt lgkmcnt(0)
  v_mfma_f32_16x16x32_bf16 v[224:227], v[160:163], v[128:131], 0
  v_mfma_f32_16x16x32_bf16 v[224:227], v[164:167], v[132:135], v[224:227]
  v_mfma_f32_16x16x32_bf16 v[224:227], v[168:171], v[136:139], v[224:227]
  v_mfma_f32_16x16x32_bf16 v[224:227], v[172:175], v[140:143], v[224:227]
  v_mfma_f32_16x16x32_bf16 v[224:227], v[176:179], v[144:147], v[224:227]
  v_mfma_f32_16x16x32_bf16 v[224:227], v[180:183], v[148:151], v[224:227]
  v_mfma_f32_16x16x32_bf16 v[224:227], v[184:187], v[152:155], v[224:227]
  v_mfma_f32_16x16x32_bf16 v[224:227], v[188:191], v[156:159], v[224:227]
  ds_read_b128 v[192:195], v107 offset:0
  ds_read_b128 v[196:199], v107 offset:64
  ds_read_b128 v[200:203], v107 offset:128
  ds_read_b128 v[204:207], v107 offset:192
  ds_read_b128 v[208:211], v107 offset:256
  ds_read_b128 v[212:215], v107 offset:320
  ds_read_b128 v[216:219], v107 offset:384
  ds_read_b128 v[220:223], v107 offset:448
  ds_read_b128 v[160:163], v107 offset:8448
  ds_read_b128 v[164:167], v107 offset:8512
  ds_read_b128 v[168:171], v107 offset:8576
  ds_read_b128 v[172:175], v107 offset:8640
  ds_read_b128 v[176:179], v107 offset:8704
  ds_read_b128 v[180:183], v107 offset:8768
  ds_read_b128 v[184:187], v107 offset:8832
  ds_read_b128 v[188:191], v107 offset:8896
  s_waitcnt lgkmcnt(8)
  v_mfma_f32_16x16x32_bf16 v[228:231], v[192:195], v[128:131], 0
  v_mfma_f32_16x16x32_bf16 v[228:231], v[196:199], v[132:135], v[228:231]
  v_mfma_f32_16x16x32_bf16 v[228:231], v[200:203], v[136:139], v[228:231]
  v_mfma_f32_16x16x32_bf16 v[228:231], v[204:207], v[140:143], v[228:231]
  v_mfma_f32_16x16x32_bf16 v[228:231], v[208:211], v[144:147], v[228:231]
  v_mfma_f32_16x16x32_bf16 v[228:231], v[212:215], v[148:151], v[228:231]
  v_mfma_f32_16x16x32_bf16 v[228:231], v[216:219], v[152:155], v[228:231]
  v_mfma_f32_16x16x32_bf16 v[228:231], v[220:223], v[156:159], v[228:231]
  s_waitcnt lgkmcnt(0)
  v_mfma_f32_16x16x32_bf16 v[232:235], v[160:163], v[128:131], 0
  v_mfma_f32_16x16x32_bf16 v[232:235], v[164:167], v[132:135], v[232:235]
  v_mfma_f32_16x16x32_bf16 v[232:235], v[168:171], v[136:139], v[232:235]
  v_mfma_f32_16x16x32_bf16 v[232:235], v[172:175], v[140:143], v[232:235]
  v_mfma_f32_16x16x32_bf16 v[232:235], v[176:179], v[144:147], v[232:235]
  v_mfma_f32_16x16x32_bf16 v[232:235], v[180:183], v[148:151], v[232:235]
  v_mfma_f32_16x16x32_bf16 v[232:235], v[184:187], v[152:155], v[232:235]
  v_mfma_f32_16x16x32_bf16 v[232:235], v[188:191], v[156:159], v[232:235]
  v_lshlrev_b32 v122, 3, v0
  v_add_u32 v122, 112128, v122
  s_nop 7
  v_cvt_pk_bf16_f32 v60, v224, v225
  v_cvt_pk_bf16_f32 v61, v226, v227
  v_cvt_pk_bf16_f32 v62, v228, v229
  v_cvt_pk_bf16_f32 v63, v230, v231
  v_cvt_pk_bf16_f32 v64, v232, v233
  v_cvt_pk_bf16_f32 v65, v234, v235
  ds_write_b64 v18, v[60:61]
  ds_write_b64 v19, v[62:63]
  ds_write_b32 v20, v64
  ds_write_b32 v20, v65 offset:64
  s_waitcnt lgkmcnt(0)
  s_barrier
  ds_read_u16 v128, v8 offset:0
  ds_read_u16 v129, v9 offset:0
  ds_read_u16 v130, v10 offset:0
  ds_read_u16 v131, v11 offset:0
  ds_read_u16 v132, v12 offset:0
  ds_read_u16 v133, v13 offset:0
  ds_read_u16 v134, v14 offset:0
  ds_read_u16 v135, v15 offset:0
  ds_read_u16 v136, v16 offset:0
  ds_read_u16 v137, v17 offset:0
  ds_read_u16 v138, v8 offset:1536
  ds_read_u16 v139, v9 offset:1536
  ds_read_u16 v140, v10 offset:1536
  ds_read_u16 v141, v11 offset:1536
  ds_read_u16 v142, v12 offset:1536
  ds_read_u16 v143, v13 offset:1536
  ds_read_u16 v144, v14 offset:1536
  ds_read_u16 v145, v15 offset:1536
  ds_read_u16 v146, v16 offset:1536
  ds_read_u16 v147, v17 offset:1536
  ds_read_u16 v148, v8 offset:3072
  ds_read_u16 v149, v9 offset:3072
  ds_read_u16 v150, v10 offset:3072
  ds_read_u16 v151, v11 offset:3072
  ds_read_u16 v152, v12 offset:3072
  ds_read_u16 v153, v13 offset:3072
  ds_read_u16 v154, v14 offset:3072
  ds_read_u16 v155, v15 offset:3072
  ds_read_u16 v156, v16 offset:3072
  ds_read_u16 v157, v17 offset:3072
  ds_read_u16 v158, v8 offset:4608
  ds_read_u16 v159, v9 offset:4608
  ds_read_u16 v160, v10 offset:4608
  ds_read_u16 v161, v11 offset:4608
  ds_read_u16 v162, v12 offset:4608
  ds_read_u16 v163, v13 offset:4608
  ds_read_u16 v164, v14 offset:4608
  ds_read_u16 v165, v15 offset:4608
  ds_read_u16 v166, v16 offset:4608
  ds_read_u16 v167, v17 offset:4608
  s_waitcnt lgkmcnt(15)
  v_lshl_or_b32 v168, v129, 16, v128
  v_lshl_or_b32 v169, v131, 16, v130
  v_lshl_or_b32 v170, v130, 16, v129
  v_lshl_or_b32 v171, v132, 16, v131
  v_lshl_or_b32 v172, v134, 16, v133
  v_lshl_or_b32 v173, v136, 16, v135
  v_lshl_or_b32 v174, v135, 16, v134
  v_lshl_or_b32 v175, v137, 16, v136
  s_waitcnt lgkmcnt(15)
  v_lshl_or_b32 v176, v139, 16, v138
  v_lshl_or_b32 v177, v141, 16, v140
  v_lshl_or_b32 v178, v140, 16, v139
  v_lshl_or_b32 v179, v142, 16, v141
  v_lshl_or_b32 v180, v144, 16, v143
  v_lshl_or_b32 v181, v146, 16, v145
  v_lshl_or_b32 v182, v145, 16, v144
  v_lshl_or_b32 v183, v147, 16, v146
  s_waitcnt lgkmcnt(10)
  v_lshl_or_b32 v184, v149, 16, v148
  v_lshl_or_b32 v185, v151, 16, v150
  v_lshl_or_b32 v186, v150, 16, v149
  v_lshl_or_b32 v187, v152, 16, v151
  v_lshl_or_b32 v188, v154, 16, v153
  v_lshl_or_b32 v189, v156, 16, v155
  v_lshl_or_b32 v190, v155, 16, v154
  v_lshl_or_b32 v191, v157, 16, v156
  s_waitcnt lgkmcnt(0)
  v_lshl_or_b32 v192, v159, 16, v158
  v_lshl_or_b32 v193, v161, 16, v160
  v_lshl_or_b32 v194, v160, 16, v159
  v_lshl_or_b32 v195, v162, 16, v161
  v_lshl_or_b32 v196, v164, 16, v163
  v_lshl_or_b32 v197, v166, 16, v165
  v_lshl_or_b32 v198, v165, 16, v164
  v_lshl_or_b32 v199, v167, 16, v166
  ds_write_b64 v122, v[168:169] offset:0
  ds_write_b64 v122, v[170:171] offset:4160
  ds_write_b64 v122, v[172:173] offset:2048
  ds_write_b64 v122, v[174:175] offset:6208
  ds_write_b64 v122, v[176:177] offset:8320
  ds_write_b64 v122, v[178:179] offset:12480
  ds_write_b64 v122, v[180:181] offset:10368
  ds_write_b64 v122, v[182:183] offset:14528
  ds_write_b64 v122, v[184:185] offset:16640
  ds_write_b64 v122, v[186:187] offset:20800
  ds_write_b64 v122, v[188:189] offset:18688
  ds_write_b64 v122, v[190:191] offset:22848
  ds_write_b64 v122, v[192:193] offset:24960
  ds_write_b64 v122, v[194:195] offset:29120
  ds_write_b64 v122, v[196:197] offset:27008
  ds_write_b64 v122, v[198:199] offset:31168
  v_lshlrev_b32 v123, 1, v2
  v_sub_u32 v123, 4062, v123
  v_lshl_add_u32 v123, v3, 4, v123
  v_and_b32 v124, 1, v2
  v_cmp_eq_u32 vcc, 0, v124
  v_mov_b32 v124, 4158
  s_nop 0
  v_cndmask_b32 v124, 0, v124, vcc
  v_add_u32 v123, v123, v124
  s_mul_i32 s70, s3, 8320
  s_add_u32 s70, s70, 112128
  s_sub_u32 s71, s70, 512
  v_add_u32 v124, s71, v123
  s_sub_u32 s71, s70, 1536
  v_add_u32 v125, s71, v123
  s_sub_u32 s71, s70, 2560
  v_add_u32 v126, s71, v123
  s_sub_u32 s71, s70, 3584
  v_add_u32 v127, s71, v123
  s_mul_i32 s70, s3, 4608
  s_add_u32 s70, s70, 145888
  v_lshlrev_b32 v119, 5, v2
  v_lshl_add_u32 v119, v3, 4, v119
  v_add_u32 v119, s70, v119
  s_mov_b32 s64, 128
  s_cmp_lg_u32 s3, 0
  s_cbranch_scc1 sequential_preLN__ssm_conv_s4__dense_activation_mish__prompt_kernel_pskip_11
  v_mov_b32 v7, 0
  s_mov_b64 exec, 1
  s_mov_b32 s66, 0
sequential_preLN__ssm_conv_s4__dense_activation_mish__prompt_kernel_poll_9:
  buffer_load_dword v4, v7, s[12:15], s64 offen sc1
  s_add_u32 s66, s66, 1
  s_waitcnt vmcnt(0)
  v_cmp_gt_u32 vcc, 1, v4
  s_cmp_gt_u32 s66, 400000
  s_cbranch_scc1 sequential_preLN__ssm_conv_s4__dense_activation_mish__prompt_kernel_polled_10
  s_cbranch_vccz sequential_preLN__ssm_conv_s4__dense_activation_mish__prompt_kernel_polled_10
  s_sleep 1
  s_branch sequential_preLN__ssm_conv_s4__dense_activation_mish__prompt_kernel_poll_9
sequential_preLN__ssm_conv_s4__dense_activation_mish__prompt_kernel_polled_10:
  s_mov_b64 exec, -1
sequential_preLN__ssm_conv_s4__dense_activation_mish__prompt_kernel_pskip_11:
  s_barrier
  v_lshlrev_b32 v6, 4, v0
  s_lshl_b32 s71, s4, 14
  s_add_u32 s71, s71, 11976704
  s_mov_b32 s70, 0
  buffer_load_dwordx4 v[24:27], v6, s[8:11], s70 offen sc1
  s_mov_b32 s70, 4096
  buffer_load_dwordx4 v[28:31], v6, s[8:11], s70 offen sc1
  s_mov_b32 s70, 8192
  buffer_load_dwordx4 v[32:35], v6, s[8:11], s70 offen sc1
  s_mov_b32 s70, 12288
  buffer_load_dwordx4 v[36:39], v6, s[8:11], s70 offen sc1
  ds_read2_b32 v[224:225], v124 offset0:128 offset1:129
  ds_read2_b32 v[226:227], v124 offset0:130 offset1:131
  ds_read2_b32 v[228:229], v124 offset0:0 offset1:1
  ds_read2_b32 v[230:231], v124 offset0:2 offset1:3
  ds_read2_b32 v[232:233], v125 offset0:128 offset1:129
  ds_read2_b32 v[234:235], v125 offset0:130 offset1:131
  ds_read2_b32 v[236:237], v125 offset0:0 offset1:1
  ds_read2_b32 v[238:239], v125 offset0:2 offset1:3
  ds_read2_b32 v[240:241], v126 offset0:128 offset1:129
  ds_read2_b32 v[242:243], v126 offset0:130 offset1:131
  ds_read2_b32 v[244:245], v126 offset0:0 offset1:1
  ds_read2_b32 v[246:247], v126 offset0:2 offset1:3
  ds_read2_b32 v[248:249], v127 offset0:128 offset1:129
  v_subrev_u32 v124, 64, v124
  v_subrev_u32 v125, 64, v125
  v_subrev_u32 v126, 64, v126
  v_add_u32 v57, 0, v1
  v_mul_u32_u24 v58, 4682, v57
  v_lshrrev_b32 v58, 16, v58
  v_mul_u32_u24 v59, 14, v58
  v_sub_u32 v57, v57, v59
  v_mul_u32_u24 v58, 3456, v58
  v_lshl_add_u32 v100, v57, 4, v58
  v_add_u32 v57, 64, v1
  v_mul_u32_u24 v58, 4682, v57
  v_lshrrev_b32 v58, 16, v58
  v_mul_u32_u24 v59, 14, v58
  v_sub_u32 v57, v57, v59
  v_mul_u32_u24 v58, 3456, v58
  v_lshl_add_u32 v101, v57, 4, v58
  v_add_u32 v57, 128, v1
  v_mul_u32_u24 v58, 4682, v57
  v_lshrrev_b32 v58, 16, v58
  v_mul_u32_u24 v59, 14, v58
  v_sub_u32 v57, v57, v59
  v_mul_u32_u24 v58, 3456, v58
  v_lshl_add_u32 v102, v57, 4, v58
  v_add_u32 v57, 192, v1
  v_mul_u32_u24 v58, 4682, v57
  v_lshrrev_b32 v58, 16, v58
  v_mul_u32_u24 v59, 14, v58
  v_sub_u32 v57, v57, v59
  v_mul_u32_u24 v58, 3456, v58
  v_lshl_add_u32 v103, v57, 4, v58
  v_add_u32 v57, 256, v1
  v_mul_u32_u24 v58, 4682, v57
  v_lshrrev_b32 v58, 16, v58
  v_mul_u32_u24 v59, 14, v58
  v_sub_u32 v57, v57, v59
  v_mul_u32_u24 v58, 3456, v58
  v_lshl_add_u32 v104, v57, 4, v58
  v_add_u32 v57, 320, v1
  v_mul_u32_u24 v58, 4682, v57
  v_lshrrev_b32 v58, 16, v58
  v_mul_u32_u24 v59, 14, v58
  v_sub_u32 v57, v57, v59
  v_mul_u32_u24 v58, 3456, v58
  v_lshl_add_u32 v105, v57, 4, v58
  v_add_u32 v57, 384, v1
  v_mul_u32_u24 v58, 4682, v57
  v_lshrrev_b32 v58, 16, v58
  v_mul_u32_u24 v59, 14, v58
  v_sub_u32 v57, v57, v59
  v_mul_u32_u24 v58, 3456, v58
  v_lshl_add_u32 v106, v57, 4, v58
  v_mov_b32 v128, 0
  v_mov_b32 v129, 0
  v_mov_b32 v130, 0
  v_mov_b32 v131, 0
  v_mov_b32 v132, 0
  v_mov_b32 v133, 0
  v_mov_b32 v134, 0
  v_mov_b32 v135, 0
  v_mov_b32 v136, 0
  v_mov_b32 v137, 0
  v_mov_b32 v138, 0
  v_mov_b32 v139, 0
  v_mov_b32 v140, 0
  v_mov_b32 v141, 0
  v_mov_b32 v142, 0
  v_mov_b32 v143, 0
  v_mov_b32 v144, 0
  v_mov_b32 v145, 0
  v_mov_b32 v146, 0
  v_mov_b32 v147, 0
  v_mov_b32 v148, 0
  v_mov_b32 v149, 0
  v_mov_b32 v150, 0
  v_mov_b32 v151, 0
  v_mov_b32 v152, 0
  v_mov_b32 v153, 0
  v_mov_b32 v154, 0
  v_mov_b32 v155, 0
  v_mov_b32 v156, 0
  v_mov_b32 v157, 0
  v_mov_b32 v158, 0
  v_mov_b32 v159, 0
  v_lshlrev_b32 v7, 2, v0
  v_add_u32 v7, 145920, v7
  s_waitcnt vmcnt(3)
  v_mul_f32 v24, -v24, v25
  v_mul_f32 v26, -v26, v27
  v_lshlrev_b32 v56, 16, v40
  v_and_b32 v57, 0xffff0000, v40
  v_lshlrev_b32 v58, 16, v41
  v_and_b32 v59, 0xffff0000, v41
  v_lshlrev_b32 v60, 16, v42
  v_and_b32 v61, 0xffff0000, v42
  v_lshlrev_b32 v62, 16, v43
  v_and_b32 v63, 0xffff0000, v43
  v_pk_fma_f32 v[56:57], v[56:57], v[24:25], v[24:25] op_sel:[0,1,0] op_sel_hi:[1,1,0]
  v_pk_fma_f32 v[58:59], v[58:59], v[24:25], v[24:25] op_sel:[0,1,0] op_sel_hi:[1,1,0]
  v_pk_fma_f32 v[60:61], v[60:61], v[26:27], v[26:27] op_sel:[0,1,0] op_sel_hi:[1,1,0]
  v_pk_fma_f32 v[62:63], v[62:63], v[26:27], v[26:27] op_sel:[0,1,0] op_sel_hi:[1,1,0]
  v_cvt_pk_bf16_f32 v8, v56, v60
  ds_write_b32 v7, v8 offset:0
  v_cvt_pk_bf16_f32 v9, v57, v61
  ds_write_b32 v7, v9 offset:4608
  v_cvt_pk_bf16_f32 v10, v58, v62
  ds_write_b32 v7, v10 offset:9216
  v_cvt_pk_bf16_f32 v11, v59, v63
  ds_write_b32 v7, v11 offset:13824
  s_waitcnt vmcnt(2)
  v_mul_f32 v28, -v28, v29
  v_mul_f32 v30, -v30, v31
  v_lshlrev_b32 v56, 16, v44
  v_and_b32 v57, 0xffff0000, v44
  v_lshlrev_b32 v58, 16, v45
  v_and_b32 v59, 0xffff0000, v45
  v_lshlrev_b32 v60, 16, v46
  v_and_b32 v61, 0xffff0000, v46
  v_lshlrev_b32 v62, 16, v47
  v_and_b32 v63, 0xffff0000, v47
  v_pk_fma_f32 v[56:57], v[56:57], v[28:29], v[28:29] op_sel:[0,1,0] op_sel_hi:[1,1,0]
  v_pk_fma_f32 v[58:59], v[58:59], v[28:29], v[28:29] op_sel:[0,1,0] op_sel_hi:[1,1,0]
  v_pk_fma_f32 v[60:61], v[60:61], v[30:31], v[30:31] op_sel:[0,1,0] op_sel_hi:[1,1,0]
  v_pk_fma_f32 v[62:63], v[62:63], v[30:31], v[30:31] op_sel:[0,1,0] op_sel_hi:[1,1,0]
  v_cvt_pk_bf16_f32 v12, v56, v60
  ds_write_b32 v7, v12 offset:1024
  v_cvt_pk_bf16_f32 v13, v57, v61
  ds_write_b32 v7, v13 offset:5632
  v_cvt_pk_bf16_f32 v14, v58, v62
  ds_write_b32 v7, v14 offset:10240
  v_cvt_pk_bf16_f32 v15, v59, v63
  ds_write_b32 v7, v15 offset:14848
  s_waitcnt vmcnt(1)
  v_mul_f32 v32, -v32, v33
  v_mul_f32 v34, -v34, v35
  v_lshlrev_b32 v56, 16, v48
  v_and_b32 v57, 0xffff0000, v48
  v_lshlrev_b32 v58, 16, v49
  v_and_b32 v59, 0xffff0000, v49
  v_lshlrev_b32 v60, 16, v50
  v_and_b32 v61, 0xffff0000, v50
  v_lshlrev_b32 v62, 16, v51
  v_and_b32 v63, 0xffff0000, v51
  v_pk_fma_f32 v[56:57], v[56:57], v[32:33], v[32:33] op_sel:[0,1,0] op_sel_hi:[1,1,0]
  v_pk_fma_f32 v[58:59], v[58:59], v[32:33], v[32:33] op_sel:[0,1,0] op_sel_hi:[1,1,0]
  v_pk_fma_f32 v[60:61], v[60:61], v[34:35], v[34:35] op_sel:[0,1,0] op_sel_hi:[1,1,0]
  v_pk_fma_f32 v[62:63], v[62:63], v[34:35], v[34:35] op_sel:[0,1,0] op_sel_hi:[1,1,0]
  v_cvt_pk_bf16_f32 v16, v56, v60
  ds_write_b32 v7, v16 offset:2048
  v_cvt_pk_bf16_f32 v17, v57, v61
  ds_write_b32 v7, v17 offset:6656
  v_cvt_pk_bf16_f32 v18, v58, v62
  ds_write_b32 v7, v18 offset:11264
  v_cvt_pk_bf16_f32 v19, v59, v63
  ds_write_b32 v7, v19 offset:15872
  s_waitcnt vmcnt(0)
  v_mul_f32 v36, -v36, v37
  v_mul_f32 v38, -v38, v39
  v_lshlrev_b32 v56, 16, v52
  v_and_b32 v57, 0xffff0000, v52
  v_lshlrev_b32 v58, 16, v53
  v_and_b32 v59, 0xffff0000, v53
  v_lshlrev_b32 v60, 16, v54
  v_and_b32 v61, 0xffff0000, v54
  v_lshlrev_b32 v62, 16, v55
  v_and_b32 v63, 0xffff0000, v55
  v_pk_fma_f32 v[56:57], v[56:57], v[36:37], v[36:37] op_sel:[0,1,0] op_sel_hi:[1,1,0]
  v_pk_fma_f32 v[58:59], v[58:59], v[36:37], v[36:37] op_sel:[0,1,0] op_sel_hi:[1,1,0]
  v_pk_fma_f32 v[60:61], v[60:61], v[38:39], v[38:39] op_sel:[0,1,0] op_sel_hi:[1,1,0]
  v_pk_fma_f32 v[62:63], v[62:63], v[38:39], v[38:39] op_sel:[0,1,0] op_sel_hi:[1,1,0]
  v_cvt_pk_bf16_f32 v20, v56, v60
  ds_write_b32 v7, v20 offset:3072
  v_cvt_pk_bf16_f32 v21, v57, v61
  ds_write_b32 v7, v21 offset:7680
  v_cvt_pk_bf16_f32 v22, v58, v62
  ds_write_b32 v7, v22 offset:12288
  v_cvt_pk_bf16_f32 v23, v59, v63
  ds_write_b32 v7, v23 offset:16896
  s_waitcnt lgkmcnt(0)
  s_barrier
  ds_read_b128 v[160:163], v119 offset:0
  ds_read_b128 v[164:167], v119 offset:512
  ds_read_b128 v[168:171], v119 offset:1024
  ds_read_b128 v[172:175], v119 offset:1536
  ds_read_b128 v[176:179], v119 offset:2048
  ds_read_b128 v[180:183], v119 offset:2560
  ds_read_b128 v[184:187], v119 offset:3072
  ds_read_b128 v[188:191], v119 offset:3584
  v_subrev_u32 v119, 64, v119
  s_waitcnt lgkmcnt(0)
  s_mov_b32 s70, 0
  s_add_u32 s68, s3, 0
  s_mul_i32 s72, s68, 110592
  s_lshl_b32 s73, s51, 5
  s_add_u32 s72, s72, s73
  s_mul_i32 s73, s68, 7168
conv_loop:
  s_waitcnt lgkmcnt(1)
  v_mfma_f32_16x16x32_bf16 v[128:131], v[224:227], v[160:163], v[128:131]
  ds_read2_b32 v[250:251], v127 offset0:130 offset1:131
  ds_read_b128 v[192:195], v119 offset:0
  v_mfma_f32_16x16x32_bf16 v[132:135], v[224:227], v[164:167], v[132:135]
  ds_read2_b32 v[252:253], v127 offset0:0 offset1:1
  ds_read_b128 v[196:199], v119 offset:512
  v_mfma_f32_16x16x32_bf16 v[136:139], v[224:227], v[168:171], v[136:139]
  ds_read2_b32 v[254:255], v127 offset0:2 offset1:3
  ds_read_b128 v[200:203], v119 offset:1024
  v_mfma_f32_16x16x32_bf16 v[140:143], v[224:227], v[172:175], v[140:143]
  v_subrev_u32 v127, 64, v127
  ds_read_b128 v[204:207], v119 offset:1536
  v_mfma_f32_16x16x32_bf16 v[144:147], v[224:227], v[176:179], v[144:147]
  ds_read_b128 v[208:211], v119 offset:2048
  v_mfma_f32_16x16x32_bf16 v[148:151], v[224:227], v[180:183], v[148:151]
  ds_read_b128 v[212:215], v119 offset:2560
  v_mfma_f32_16x16x32_bf16 v[152:155], v[224:227], v[184:187], v[152:155]
  ds_read_b128 v[216:219], v119 offset:3072
  v_mfma_f32_16x16x32_bf16 v[156:159], v[224:227], v[188:191], v[156:159]
  ds_read_b128 v[220:223], v119 offset:3584
  v_mfma_f32_16x16x32_bf16 v[132:135], v[228:231], v[160:163], v[132:135]
  v_subrev_u32 v119, 64, v119
  ds_read2_b32 v[224:225], v124 offset0:128 offset1:129
  v_mfma_f32_16x16x32_bf16 v[136:139], v[228:231], v[164:167], v[136:139]
  ds_read2_b32 v[226:227], v124 offset0:130 offset1:131
  v_mfma_f32_16x16x32_bf16 v[140:143], v[228:231], v[168:171], v[140:143]
  v_mfma_f32_16x16x32_bf16 v[144:147], v[228:231], v[172:175], v[144:147]
  s_add_u32 m0, s73, 0
  s_nop 0
  buffer_load_dwordx4 v100, s[24:27], s72 offen lds
  v_mfma_f32_16x16x32_bf16 v[148:151], v[228:231], v[176:179], v[148:151]
  s_add_u32 m0, s73, 3072
  s_nop 0
  buffer_load_dwordx4 v103, s[24:27], s72 offen lds
  v_mfma_f32_16x16x32_bf16 v[152:155], v[228:231], v[180:183], v[152:155]
  v_mfma_f32_16x16x32_bf16 v[156:159], v[228:231], v[184:187], v[156:159]
  v_mfma_f32_16x16x32_bf16 v[136:139], v[232:235], v[160:163], v[136:139]
  ds_read2_b32 v[228:229], v124 offset0:0 offset1:1
  v_mfma_f32_16x16x32_bf16 v[140:143], v[232:235], v[164:167], v[140:143]
  ds_read2_b32 v[230:231], v124 offset0:2 offset1:3
  v_mfma_f32_16x16x32_bf16 v[144:147], v[232:235], v[168:171], v[144:147]
  v_subrev_u32 v124, 64, v124
  v_mfma_f32_16x16x32_bf16 v[148:151], v[232:235], v[172:175], v[148:151]
  s_add_u32 m0, s73, 1024
  s_nop 0
  buffer_load_dwordx4 v101, s[24:27], s72 offen lds
  v_mfma_f32_16x16x32_bf16 v[152:155], v[232:235], v[176:179], v[152:155]
  v_mfma_f32_16x16x32_bf16 v[156:159], v[232:235], v[180:183], v[156:159]
  v_mfma_f32_16x16x32_bf16 v[140:143], v[236:239], v[160:163], v[140:143]
  ds_read2_b32 v[232:233], v125 offset0:128 offset1:129
  v_mfma_f32_16x16x32_bf16 v[144:147], v[236:239], v[164:167], v[144:147]
  ds_read2_b32 v[234:235], v125 offset0:130 offset1:131
  v_mfma_f32_16x16x32_bf16 v[148:151], v[236:239], v[168:171], v[148:151]
  s_add_u32 m0, s73, 2048
  s_nop 0
  buffer_load_dwordx4 v102, s[24:27], s72 offen lds
  v_mfma_f32_16x16x32_bf16 v[152:155], v[236:239], v[172:175], v[152:155]
  v_mfma_f32_16x16x32_bf16 v[156:159], v[236:239], v[176:179], v[156:159]
  v_mfma_f32_16x16x32_bf16 v[144:147], v[240:243], v[160:163], v[144:147]
  ds_read2_b32 v[236:237], v125 offset0:0 offset1:1
  v_mfma_f32_16x16x32_bf16 v[148:151], v[240:243], v[164:167], v[148:151]
  ds_read2_b32 v[238:239], v125 offset0:2 offset1:3
  v_mfma_f32_16x16x32_bf16 v[152:155], v[240:243], v[168:171], v[152:155]
  v_subrev_u32 v125, 64, v125
  v_mfma_f32_16x16x32_bf16 v[156:159], v[240:243], v[172:175], v[156:159]
  v_mfma_f32_16x16x32_bf16 v[148:151], v[244:247], v[160:163], v[148:151]
  ds_read2_b32 v[240:241], v126 offset0:128 offset1:129
  v_mfma_f32_16x16x32_bf16 v[152:155], v[244:247], v[164:167], v[152:155]
  ds_read2_b32 v[242:243], v126 offset0:130 offset1:131
  v_mfma_f32_16x16x32_bf16 v[156:159], v[244:247], v[168:171], v[156:159]
  s_waitcnt lgkmcnt(12)
  v_mfma_f32_16x16x32_bf16 v[152:155], v[248:251], v[160:163], v[152:155]
  ds_read2_b32 v[244:245], v126 offset0:0 offset1:1
  v_mfma_f32_16x16x32_bf16 v[156:159], v[248:251], v[164:167], v[156:159]
  ds_read2_b32 v[246:247], v126 offset0:2 offset1:3
  v_mfma_f32_16x16x32_bf16 v[156:159], v[252:255], v[160:163], v[156:159]
  v_subrev_u32 v126, 64, v126
  ds_read2_b32 v[248:249], v127 offset0:128 offset1:129
  s_waitcnt lgkmcnt(1)
  v_mfma_f32_16x16x32_bf16 v[128:131], v[224:227], v[192:195], v[128:131]
  ds_read2_b32 v[250:251], v127 offset0:130 offset1:131
  ds_read_b128 v[160:163], v119 offset:0
  v_mfma_f32_16x16x32_bf16 v[132:135], v[224:227], v[196:199], v[132:135]
  ds_read2_b32 v[252:253], v127 offset0:0 offset1:1
  ds_read_b128 v[164:167], v119 offset:512
  v_mfma_f32_16x16x32_bf16 v[136:139], v[224:227], v[200:203], v[136:139]
  ds_read2_b32 v[254:255], v127 offset0:2 offset1:3
  ds_read_b128 v[168:171], v119 offset:1024
  v_mfma_f32_16x16x32_bf16 v[140:143], v[224:227], v[204:207], v[140:143]
  v_subrev_u32 v127, 64, v127
  ds_read_b128 v[172:175], v119 offset:1536
  v_mfma_f32_16x16x32_bf16 v[144:147], v[224:227], v[208:211], v[144:147]
  ds_read_b128 v[176:179], v119 offset:2048
  v_mfma_f32_16x16x32_bf16 v[148:151], v[224:227], v[212:215], v[148:151]
  ds_read_b128 v[180:183], v119 offset:2560
  v_mfma_f32_16x16x32_bf16 v[152:155], v[224:227], v[216:219], v[152:155]
  ds_read_b128 v[184:187], v119 offset:3072
  v_mfma_f32_16x16x32_bf16 v[156:159], v[224:227], v[220:223], v[156:159]
  ds_read_b128 v[188:191], v119 offset:3584
  v_mfma_f32_16x16x32_bf16 v[132:135], v[228:231], v[192:195], v[132:135]
  v_subrev_u32 v119, 64, v119
  ds_read2_b32 v[224:225], v124 offset0:128 offset1:129
  v_mfma_f32_16x16x32_bf16 v[136:139], v[228:231], v[196:199], v[136:139]
  ds_read2_b32 v[226:227], v124 offset0:130 offset1:131
  v_mfma_f32_16x16x32_bf16 v[140:143], v[228:231], v[200:203], v[140:143]
  v_mfma_f32_16x16x32_bf16 v[144:147], v[228:231], v[204:207], v[144:147]
  s_add_u32 m0, s73, 4096
  s_nop 0
  buffer_load_dwordx4 v104, s[24:27], s72 offen lds
  v_mfma_f32_16x16x32_bf16 v[148:151], v[228:231], v[208:211], v[148:151]
  v_mfma_f32_16x16x32_bf16 v[152:155], v[228:231], v[212:215], v[152:155]
  v_mfma_f32_16x16x32_bf16 v[156:159], v[228:231], v[216:219], v[156:159]
  v_mfma_f32_16x16x32_bf16 v[136:139], v[232:235], v[192:195], v[136:139]
  ds_read2_b32 v[228:229], v124 offset0:0 offset1:1
  v_mfma_f32_16x16x32_bf16 v[140:143], v[232:235], v[196:199], v[140:143]
  ds_read2_b32 v[230:231], v124 offset0:2 offset1:3
  v_mfma_f32_16x16x32_bf16 v[144:147], v[232:235], v[200:203], v[144:147]
  v_subrev_u32 v124, 64, v124
  v_mfma_f32_16x16x32_bf16 v[148:151], v[232:235], v[204:207], v[148:151]
  s_add_u32 m0, s73, 5120
  s_nop 0
  buffer_load_dwordx4 v105, s[24:27], s72 offen lds
  v_mfma_f32_16x16x32_bf16 v[152:155], v[232:235], v[208:211], v[152:155]
  v_mfma_f32_16x16x32_bf16 v[156:159], v[232:235], v[212:215], v[156:159]
  v_mfma_f32_16x16x32_bf16 v[140:143], v[236:239], v[192:195], v[140:143]
  ds_read2_b32 v[232:233], v125 offset0:128 offset1:129
  v_mfma_f32_16x16x32_bf16 v[144:147], v[236:239], v[196:199], v[144:147]
  ds_read2_b32 v[234:235], v125 offset0:130 offset1:131
  v_mfma_f32_16x16x32_bf16 v[148:151], v[236:239], v[200:203], v[148:151]
  s_add_u32 m0, s73, 6144
  s_nop 0
  buffer_load_dwordx4 v106, s[24:27], s72 offen lds
  v_mfma_f32_16x16x32_bf16 v[152:155], v[236:239], v[204:207], v[152:155]
  v_mfma_f32_16x16x32_bf16 v[156:159], v[236:239], v[208:211], v[156:159]
  v_mfma_f32_16x16x32_bf16 v[144:147], v[240:243], v[192:195], v[144:147]
  ds_read2_b32 v[236:237], v125 offset0:0 offset1:1
  v_mfma_f32_16x16x32_bf16 v[148:151], v[240:243], v[196:199], v[148:151]
  ds_read2_b32 v[238:239], v125 offset0:2 offset1:3
  v_mfma_f32_16x16x32_bf16 v[152:155], v[240:243], v[200:203], v[152:155]
  v_subrev_u32 v125, 64, v125
  v_mfma_f32_16x16x32_bf16 v[156:159], v[240:243], v[204:207], v[156:159]
  v_mfma_f32_16x16x32_bf16 v[148:151], v[244:247], v[192:195], v[148:151]
  ds_read2_b32 v[240:241], v126 offset0:128 offset1:129
  v_mfma_f32_16x16x32_bf16 v[152:155], v[244:247], v[196:199], v[152:155]
  ds_read2_b32 v[242:243], v126 offset0:130 offset1:131
  v_mfma_f32_16x16x32_bf16 v[156:159], v[244:247], v[200:203], v[156:159]
  s_waitcnt lgkmcnt(12)
  v_mfma_f32_16x16x32_bf16 v[152:155], v[248:251], v[192:195], v[152:155]
  ds_read2_b32 v[244:245], v126 offset0:0 offset1:1
  v_mfma_f32_16x16x32_bf16 v[156:159], v[248:251], v[196:199], v[156:159]
  ds_read2_b32 v[246:247], v126 offset0:2 offset1:3
  v_mfma_f32_16x16x32_bf16 v[156:159], v[252:255], v[192:195], v[156:159]
  v_subrev_u32 v126, 64, v126
  ds_read2_b32 v[248:249], v127 offset0:128 offset1:129
  s_add_u32 s68, s68, 4
  s_cmp_ge_u32 s68, 15
  s_cselect_b32 s68, 11, s68
  s_mul_i32 s72, s68, 110592
  s_lshl_b32 s73, s51, 5
  s_add_u32 s72, s72, s73
  s_mul_i32 s73, s68, 7168
  s_add_u32 s70, s70, 1
  s_cmp_lt_u32 s70, 3
  s_cbranch_scc1 conv_loop
  v_mov_b32 v81, 132
  buffer_load_dword v80, v81, s[12:15], 0 offen sc1
  s_lshl_b32 s74, s6, 16
  s_and_b32 s75, s6, 0xffff0000
  s_lshl_b32 s76, s7, 16
  s_and_b32 s77, s7, 0xffff0000
  s_waitcnt lgkmcnt(1)
  v_mfma_f32_16x16x32_bf16 v[128:131], v[224:227], v[160:163], v[128:131]
  ds_read2_b32 v[250:251], v127 offset0:130 offset1:131
  ds_read_b128 v[192:195], v119 offset:0
  v_lshlrev_b32 v56, 16, v40
  v_lshlrev_b32 v116, 16, v8
  v_mfma_f32_16x16x32_bf16 v[132:135], v[224:227], v[164:167], v[132:135]
  ds_read2_b32 v[252:253], v127 offset0:0 offset1:1
  ds_read_b128 v[196:199], v119 offset:512
  v_fma_f32 v56, v116, s74, v56
  v_mfma_f32_16x16x32_bf16 v[136:139], v[224:227], v[168:171], v[136:139]
  ds_read2_b32 v[254:255], v127 offset0:2 offset1:3
  ds_read_b128 v[200:203], v119 offset:1024
  v_lshlrev_b32 v57, 16, v42
  v_mfma_f32_16x16x32_bf16 v[140:143], v[224:227], v[172:175], v[140:143]
  v_subrev_u32 v127, 64, v127
  ds_read_b128 v[204:207], v119 offset:1536
  v_and_b32 v117, 0xffff0000, v8
  v_fma_f32 v57, v117, s74, v57
  v_mfma_f32_16x16x32_bf16 v[144:147], v[224:227], v[176:179], v[144:147]
  ds_read_b128 v[208:211], v119 offset:2048
  v_and_b32 v58, 0xffff0000, v40
  v_mfma_f32_16x16x32_bf16 v[148:151], v[224:227], v[180:183], v[148:151]
  ds_read_b128 v[212:215], v119 offset:2560
  v_lshlrev_b32 v116, 16, v9
  v_mfma_f32_16x16x32_bf16 v[152:155], v[224:227], v[184:187], v[152:155]
  ds_read_b128 v[216:219], v119 offset:3072
  v_fma_f32 v58, v116, s75, v58
  v_and_b32 v59, 0xffff0000, v42
  v_mfma_f32_16x16x32_bf16 v[156:159], v[224:227], v[188:191], v[156:159]
  ds_read_b128 v[220:223], v119 offset:3584
  v_and_b32 v117, 0xffff0000, v9
  v_mfma_f32_16x16x32_bf16 v[132:135], v[228:231], v[160:163], v[132:135]
  v_subrev_u32 v119, 64, v119
  ds_read2_b32 v[224:225], v124 offset0:128 offset1:129
  v_fma_f32 v59, v117, s75, v59
  v_mfma_f32_16x16x32_bf16 v[136:139], v[228:231], v[164:167], v[136:139]
  ds_read2_b32 v[226:227], v124 offset0:130 offset1:131
  v_lshlrev_b32 v60, 16, v41
  v_lshlrev_b32 v116, 16, v10
  v_mfma_f32_16x16x32_bf16 v[140:143], v[228:231], v[168:171], v[140:143]
  v_fma_f32 v60, v116, s76, v60
  v_mfma_f32_16x16x32_bf16 v[144:147], v[228:231], v[172:175], v[144:147]
  s_add_u32 m0, s73, 0
  s_nop 0
  buffer_load_dwordx4 v100, s[24:27], s72 offen lds
  v_lshlrev_b32 v61, 16, v43
  v_mfma_f32_16x16x32_bf16 v[148:151], v[228:231], v[176:179], v[148:151]
  s_add_u32 m0, s73, 3072
  s_nop 0
  buffer_load_dwordx4 v103, s[24:27], s72 offen lds
  v_and_b32 v117, 0xffff0000, v10
  v_fma_f32 v61, v117, s76, v61
  v_mfma_f32_16x16x32_bf16 v[152:155], v[228:231], v[180:183], v[152:155]
  v_and_b32 v62, 0xffff0000, v41
  v_mfma_f32_16x16x32_bf16 v[156:159], v[228:231], v[184:187], v[156:159]
  v_lshlrev_b32 v116, 16, v11
  v_mfma_f32_16x16x32_bf16 v[136:139], v[232:235], v[160:163], v[136:139]
  ds_read2_b32 v[228:229], v124 offset0:0 offset1:1
  v_fma_f32 v62, v116, s77, v62
  v_and_b32 v63, 0xffff0000, v43
  v_mfma_f32_16x16x32_bf16 v[140:143], v[232:235], v[164:167], v[140:143]
  ds_read2_b32 v[230:231], v124 offset0:2 offset1:3
  v_and_b32 v117, 0xffff0000, v11
  v_mfma_f32_16x16x32_bf16 v[144:147], v[232:235], v[168:171], v[144:147]
  v_subrev_u32 v124, 64, v124
  v_fma_f32 v63, v117, s77, v63
  v_mfma_f32_16x16x32_bf16 v[148:151], v[232:235], v[172:175], v[148:151]
  s_add_u32 m0, s73, 1024
  s_nop 0
  buffer_load_dwordx4 v101, s[24:27], s72 offen lds
  v_lshlrev_b32 v64, 16, v44
  v_lshlrev_b32 v116, 16, v12
  v_mfma_f32_16x16x32_bf16 v[152:155], v[232:235], v[176:179], v[152:155]
  v_fma_f32 v64, v116, s74, v64
  v_mfma_f32_16x16x32_bf16 v[156:159], v[232:235], v[180:183], v[156:159]
  v_lshlrev_b32 v65, 16, v46
  v_mfma_f32_16x16x32_bf16 v[140:143], v[236:239], v[160:163], v[140:143]
  ds_read2_b32 v[232:233], v125 offset0:128 offset1:129
  v_and_b32 v117, 0xffff0000, v12
  v_fma_f32 v65, v117, s74, v65
  v_mfma_f32_16x16x32_bf16 v[144:147], v[236:239], v[164:167], v[144:147]
  ds_read2_b32 v[234:235], v125 offset0:130 offset1:131
  v_and_b32 v66, 0xffff0000, v44
  v_mfma_f32_16x16x32_bf16 v[148:151], v[236:239], v[168:171], v[148:151]
  s_add_u32 m0, s73, 2048
  s_nop 0
  buffer_load_dwordx4 v102, s[24:27], s72 offen lds
  v_lshlrev_b32 v116, 16, v13
  v_mfma_f32_16x16x32_bf16 v[152:155], v[236:239], v[172:175], v[152:155]
  v_fma_f32 v66, v116, s75, v66
  v_and_b32 v67, 0xffff0000, v46
  v_mfma_f32_16x16x32_bf16 v[156:159], v[236:239], v[176:179], v[156:159]
  v_and_b32 v117, 0xffff0000, v13
  v_mfma_f32_16x16x32_bf16 v[144:147], v[240:243], v[160:163], v[144:147]
  ds_read2_b32 v[236:237], v125 offset0:0 offset1:1
  v_fma_f32 v67, v117, s75, v67
  v_mfma_f32_16x16x32_bf16 v[148:151], v[240:243], v[164:167], v[148:151]
  ds_read2_b32 v[238:239], v125 offset0:2 offset1:3
  v_lshlrev_b32 v68, 16, v45
  v_lshlrev_b32 v116, 16, v14
  v_mfma_f32_16x16x32_bf16 v[152:155], v[240:243], v[168:171], v[152:155]
  v_subrev_u32 v125, 64, v125
  v_fma_f32 v68, v116, s76, v68
  v_mfma_f32_16x16x32_bf16 v[156:159], v[240:243], v[172:175], v[156:159]
  v_lshlrev_b32 v69, 16, v47
  v_mfma_f32_16x16x32_bf16 v[148:151], v[244:247], v[160:163], v[148:151]
  ds_read2_b32 v[240:241], v126 offset0:128 offset1:129
  v_and_b32 v117, 0xffff0000, v14
  v_fma_f32 v69, v117, s76, v69
  v_mfma_f32_16x16x32_bf16 v[152:155], v[244:247], v[164:167], v[152:155]
  ds_read2_b32 v[242:243], v126 offset0:130 offset1:131
  v_and_b32 v70, 0xffff0000, v45
  v_mfma_f32_16x16x32_bf16 v[156:159], v[244:247], v[168:171], v[156:159]
  v_lshlrev_b32 v116, 16, v15
  s_waitcnt lgkmcnt(12)
  v_mfma_f32_16x16x32_bf16 v[152:155], v[248:251], v[160:163], v[152:155]
  ds_read2_b32 v[244:245], v126 offset0:0 offset1:1
  v_fma_f32 v70, v116, s77, v70
  v_and_b32 v71, 0xffff0000, v47
  v_mfma_f32_16x16x32_bf16 v[156:159], v[248:251], v[164:167], v[156:159]
  ds_read2_b32 v[246:247], v126 offset0:2 offset1:3
  v_and_b32 v117, 0xffff0000, v15
  v_mfma_f32_16x16x32_bf16 v[156:159], v[252:255], v[160:163], v[156:159]
  v_subrev_u32 v126, 64, v126
  ds_read2_b32 v[248:249], v127 offset0:128 offset1:129
  v_fma_f32 v71, v117, s77, v71
  s_waitcnt lgkmcnt(1)
  v_mfma_f32_16x16x32_bf16 v[128:131], v[224:227], v[192:195], v[128:131]
  ds_read2_b32 v[250:251], v127 offset0:130 offset1:131
  ds_read_b128 v[160:163], v119 offset:0
  v_lshlrev_b32 v72, 16, v48
  v_lshlrev_b32 v116, 16, v16
  v_mfma_f32_16x16x32_bf16 v[132:135], v[224:227], v[196:199], v[132:135]
  ds_read2_b32 v[252:253], v127 offset0:0 offset1:1
  ds_read_b128 v[164:167], v119 offset:512
  v_fma_f32 v72, v116, s74, v72
  v_mfma_f32_16x16x32_bf16 v[136:139], v[224:227], v[200:203], v[136:139]
  ds_read2_b32 v[254:255], v127 offset0:2 offset1:3
  ds_read_b128 v[168:171], v119 offset:1024
  v_lshlrev_b32 v73, 16, v50
  v_mfma_f32_16x16x32_bf16 v[140:143], v[224:227], v[204:207], v[140:143]
  v_subrev_u32 v127, 64, v127
  ds_read_b128 v[172:175], v119 offset:1536
  v_and_b32 v117, 0xffff0000, v16
  v_fma_f32 v73, v117, s74, v73
  v_mfma_f32_16x16x32_bf16 v[144:147], v[224:227], v[208:211], v[144:147]
  ds_read_b128 v[176:179], v119 offset:2048
  v_and_b32 v74, 0xffff0000, v48
  v_mfma_f32_16x16x32_bf16 v[148:151], v[224:227], v[212:215], v[148:151]
  ds_read_b128 v[180:183], v119 offset:2560
  v_lshlrev_b32 v116, 16, v17
  v_mfma_f32_16x16x32_bf16 v[152:155], v[224:227], v[216:219], v[152:155]
  ds_read_b128 v[184:187], v119 offset:3072
  v_fma_f32 v74, v116, s75, v74
  v_and_b32 v75, 0xffff0000, v50
  v_mfma_f32_16x16x32_bf16 v[156:159], v[224:227], v[220:223], v[156:159]
  ds_read_b128 v[188:191], v119 offset:3584
  v_and_b32 v117, 0xffff0000, v17
  v_mfma_f32_16x16x32_bf16 v[132:135], v[228:231], v[192:195], v[132:135]
  v_subrev_u32 v119, 64, v119
  ds_read2_b32 v[224:225], v124 offset0:128 offset1:129
  v_fma_f32 v75, v117, s75, v75
  v_mfma_f32_16x16x32_bf16 v[136:139], v[228:231], v[196:199], v[136:139]
  ds_read2_b32 v[226:227], v124 offset0:130 offset1:131
  v_lshlrev_b32 v76, 16, v49
  v_lshlrev_b32 v116, 16, v18
  v_mfma_f32_16x16x32_bf16 v[140:143], v[228:231], v[200:203], v[140:143]
  v_fma_f32 v76, v116, s76, v76
  v_mfma_f32_16x16x32_bf16 v[144:147], v[228:231], v[204:207], v[144:147]
  s_add_u32 m0, s73, 4096
  s_nop 0
  buffer_load_dwordx4 v104, s[24:27], s72 offen lds
  v_lshlrev_b32 v77, 16, v51
  v_mfma_f32_16x16x32_bf16 v[148:151], v[228:231], v[208:211], v[148:151]
  v_and_b32 v117, 0xffff0000, v18
  v_fma_f32 v77, v117, s76, v77
  v_mfma_f32_16x16x32_bf16 v[152:155], v[228:231], v[212:215], v[152:155]
  v_and_b32 v78, 0xffff0000, v49
  v_mfma_f32_16x16x32_bf16 v[156:159], v[228:231], v[216:219], v[156:159]
  v_lshlrev_b32 v116, 16, v19
  v_mfma_f32_16x16x32_bf16 v[136:139], v[232:235], v[192:195], v[136:139]
  ds_read2_b32 v[228:229], v124 offset0:0 offset1:1
  v_fma_f32 v78, v116, s77, v78
  v_and_b32 v79, 0xffff0000, v51
  v_mfma_f32_16x16x32_bf16 v[140:143], v[232:235], v[196:199], v[140:143]
  ds_read2_b32 v[230:231], v124 offset0:2 offset1:3
  v_and_b32 v117, 0xffff0000, v19
  v_mfma_f32_16x16x32_bf16 v[144:147], v[232:235], v[200:203], v[144:147]
  v_subrev_u32 v124, 64, v124
  v_fma_f32 v79, v117, s77, v79
  v_mfma_f32_16x16x32_bf16 v[148:151], v[232:235], v[204:207], v[148:151]
  s_add_u32 m0, s73, 5120
  s_nop 0
  buffer_load_dwordx4 v105, s[24:27], s72 offen lds
  v_lshlrev_b32 v108, 16, v52
  v_lshlrev_b32 v116, 16, v20
  v_mfma_f32_16x16x32_bf16 v[152:155], v[232:235], v[208:211], v[152:155]
  v_fma_f32 v108, v116, s74, v108
  v_mfma_f32_16x16x32_bf16 v[156:159], v[232:235], v[212:215], v[156:159]
  v_lshlrev_b32 v109, 16, v54
  v_mfma_f32_16x16x32_bf16 v[140:143], v[236:239], v[192:195], v[140:143]
  ds_read2_b32 v[232:233], v125 offset0:128 offset1:129
  v_and_b32 v117, 0xffff0000, v20
  v_fma_f32 v109, v117, s74, v109
  v_mfma_f32_16x16x32_bf16 v[144:147], v[236:239], v[196:199], v[144:147]
  ds_read2_b32 v[234:235], v125 offset0:130 offset1:131
  v_and_b32 v110, 0xffff0000, v52
  v_mfma_f32_16x16x32_bf16 v[148:151], v[236:239], v[200:203], v[148:151]
  s_add_u32 m0, s73, 6144
  s_nop 0
  buffer_load_dwordx4 v106, s[24:27], s72 offen lds
  v_lshlrev_b32 v116, 16, v21
  v_mfma_f32_16x16x32_bf16 v[152:155], v[236:239], v[204:207], v[152:155]
  v_fma_f32 v110, v116, s75, v110
  v_and_b32 v111, 0xffff0000, v54
  v_mfma_f32_16x16x32_bf16 v[156:159], v[236:239], v[208:211], v[156:159]
  v_and_b32 v117, 0xffff0000, v21
  v_mfma_f32_16x16x32_bf16 v[144:147], v[240:243], v[192:195], v[144:147]
  ds_read2_b32 v[236:237], v125 offset0:0 offset1:1
  v_fma_f32 v111, v117, s75, v111
  v_mfma_f32_16x16x32_bf16 v[148:151], v[240:243], v[196:199], v[148:151]
  ds_read2_b32 v[238:239], v125 offset0:2 offset1:3
  v_lshlrev_b32 v112, 16, v53
  v_lshlrev_b32 v116, 16, v22
  v_mfma_f32_16x16x32_bf16 v[152:155], v[240:243], v[200:203], v[152:155]
  v_subrev_u32 v125, 64, v125
  v_fma_f32 v112, v116, s76, v112
  v_mfma_f32_16x16x32_bf16 v[156:159], v[240:243], v[204:207], v[156:159]
  v_lshlrev_b32 v113, 16, v55
  v_mfma_f32_16x16x32_bf16 v[148:151], v[244:247], v[192:195], v[148:151]
  ds_read2_b32 v[240:241], v126 offset0:128 offset1:129
  v_and_b32 v117, 0xffff0000, v22
  v_fma_f32 v113, v117, s76, v113
  v_mfma_f32_16x16x32_bf16 v[152:155], v[244:247], v[196:199], v[152:155]
  ds_read2_b32 v[242:243], v126 offset0:130 offset1:131
  v_and_b32 v114, 0xffff0000, v53
  v_mfma_f32_16x16x32_bf16 v[156:159], v[244:247], v[200:203], v[156:159]
  v_lshlrev_b32 v116, 16, v23
  s_waitcnt lgkmcnt(12)
  v_mfma_f32_16x16x32_bf16 v[152:155], v[248:251], v[192:195], v[152:155]
  ds_read2_b32 v[244:245], v126 offset0:0 offset1:1
  v_fma_f32 v114, v116, s77, v114
  v_and_b32 v115, 0xffff0000, v55
  v_mfma_f32_16x16x32_bf16 v[156:159], v[248:251], v[196:199], v[156:159]
  ds_read2_b32 v[246:247], v126 offset0:2 offset1:3
  v_and_b32 v117, 0xffff0000, v23
  v_mfma_f32_16x16x32_bf16 v[156:159], v[252:255], v[192:195], v[156:159]
  v_subrev_u32 v126, 64, v126
  ds_read2_b32 v[248:249], v127 offset0:128 offset1:129
  v_fma_f32 v115, v117, s77, v115
  s_cmp_lg_u32 s3, 1
  s_cbranch_scc1 conv_w1
  s_waitcnt vmcnt(7)
  v_cmp_ne_u32 vcc, 0, v80
  s_cbranch_vccnz conv_wok
  v_mov_b32 v81, 132
  s_mov_b32 s66, 0
sequential_preLN__ssm_conv_s4__dense_activation_mish__prompt_kernel_spin_12:
  buffer_load_dword v80, v81, s[12:15], 0 offen sc1
  s_add_u32 s66, s66, 1
  s_waitcnt vmcnt(0)
  v_cmp_eq_u32 vcc, 0, v80
  s_cmp_gt_u32 s66, 400000
  s_cbranch_scc1 sequential_preLN__ssm_conv_s4__dense_activation_mish__prompt_kernel_spun_13
  s_cbranch_vccz sequential_preLN__ssm_conv_s4__dense_activation_mish__prompt_kernel_spun_13
  s_sleep 2
  s_branch sequential_preLN__ssm_conv_s4__dense_activation_mish__prompt_kernel_spin_12
sequential_preLN__ssm_conv_s4__dense_activation_mish__prompt_kernel_spun_13:
conv_wok:
  s_mov_b32 s28, s54
  s_mov_b32 s29, s55
  s_mov_b32 s30, 3456
  s_mov_b32 s31, 0x00020000
  v_lshlrev_b32 v91, 3, v1
  v_lshlrev_b32 v92, 2, v1
  s_lshl_b32 s66, s51, 6
  s_add_u32 s66, s66, 16384
  s_lshl_b32 s67, s51, 5
  buffer_load_dwordx2 v[82:83], v91, s[8:11], s66 offen sc1
  s_add_u32 s66, s66, 7168
  buffer_load_dwordx2 v[84:85], v91, s[8:11], s66 offen sc1
  s_add_u32 s66, s66, 7168
  buffer_load_dwordx2 v[86:87], v91, s[8:11], s66 offen sc1
  s_add_u32 s66, s66, 7168
  buffer_load_dwordx2 v[88:89], v91, s[8:11], s66 offen sc1
  buffer_load_dword v90, v92, s[28:31], s67 offen
conv_w1:
  s_waitcnt lgkmcnt(0)
  s_barrier
  s_mul_i32 s70, s3, 10240
  s_add_u32 s70, s70, 112128
  v_mul_u32_u24 v94, 80, v2
  v_lshl_add_u32 v94, v3, 4, v94
  v_add_u32 v94, s70, v94
  s_nop 4
  ds_write_b128 v94, v[128:131] offset:0
  ds_write_b128 v94, v[132:135] offset:1280
  ds_write_b128 v94, v[136:139] offset:2560
  ds_write_b128 v94, v[140:143] offset:3840
  ds_write_b128 v94, v[144:147] offset:5120
  ds_write_b128 v94, v[148:151] offset:6400
  ds_write_b128 v94, v[152:155] offset:7680
  ds_write_b128 v94, v[156:159] offset:8960
  s_waitcnt lgkmcnt(0)
  s_barrier
  v_lshrrev_b32 v95, 3, v0
  v_lshlrev_b32 v95, 4, v95
  v_lshl_add_u32 v95, v0, 3, v95
  v_add_u32 v95, 112128, v95
  ds_read_b64 v[128:129], v95 offset:0
  ds_read_b64 v[130:131], v95 offset:10240
  ds_read_b64 v[132:133], v95 offset:20480
  ds_read_b64 v[134:135], v95 offset:30720
  ds_read_b64 v[136:137], v95 offset:2560
  ds_read_b64 v[138:139], v95 offset:12800
  ds_read_b64 v[140:141], v95 offset:23040
  ds_read_b64 v[142:143], v95 offset:33280
  ds_read_b64 v[144:145], v95 offset:5120
  ds_read_b64 v[146:147], v95 offset:15360
  ds_read_b64 v[148:149], v95 offset:25600
  ds_read_b64 v[150:151], v95 offset:35840
  ds_read_b64 v[152:153], v95 offset:7680
  ds_read_b64 v[154:155], v95 offset:17920
  ds_read_b64 v[156:157], v95 offset:28160
  ds_read_b64 v[158:159], v95 offset:38400
  v_lshrrev_b32 v96, 4, v0
  v_mul_u32_u24 v96, 40960, v96
  v_and_b32 v97, 15, v0
  v_lshl_add_u32 v96, v97, 4, v96
  s_lshr_b32 s70, s4, 3
  s_lshl_b32 s70, s70, 11
  s_bfe_u32 s71, s4, 0x10002
  s_lshl_b32 s71, s71, 10
  s_add_u32 s70, s70, s71
  s_and_b32 s71, s4, 3
  s_lshl_b32 s71, s71, 8
  s_add_u32 s70, s70, s71
  s_add_u32 s70, s70, 2277376
  s_waitcnt lgkmcnt(12)
  v_pk_add_f32 v[128:129], v[128:129], v[56:57]
  v_pk_add_f32 v[130:131], v[130:131], v[58:59]
  v_pk_add_f32 v[132:133], v[132:133], v[60:61]
  v_pk_add_f32 v[134:135], v[134:135], v[62:63]
  v_cvt_pk_bf16_f32 v160, v128, v130
  v_cvt_pk_bf16_f32 v161, v132, v134
  v_cvt_pk_bf16_f32 v162, v129, v131
  v_cvt_pk_bf16_f32 v163, v133, v135
  buffer_store_dwordx4 v[160:163], v96, s[8:11], s70 offen sc1
  s_add_u32 s70, s70, 655360
  s_waitcnt lgkmcnt(8)
  v_pk_add_f32 v[136:137], v[136:137], v[64:65]
  v_pk_add_f32 v[138:139], v[138:139], v[66:67]
  v_pk_add_f32 v[140:141], v[140:141], v[68:69]
  v_pk_add_f32 v[142:143], v[142:143], v[70:71]
  v_cvt_pk_bf16_f32 v164, v136, v138
  v_cvt_pk_bf16_f32 v165, v140, v142
  v_cvt_pk_bf16_f32 v166, v137, v139
  v_cvt_pk_bf16_f32 v167, v141, v143
  buffer_store_dwordx4 v[164:167], v96, s[8:11], s70 offen sc1
  s_add_u32 s70, s70, 655360
  s_waitcnt lgkmcnt(4)
  v_pk_add_f32 v[144:145], v[144:145], v[72:73]
  v_pk_add_f32 v[146:147], v[146:147], v[74:75]
  v_pk_add_f32 v[148:149], v[148:149], v[76:77]
  v_pk_add_f32 v[150:151], v[150:151], v[78:79]
  v_cvt_pk_bf16_f32 v168, v144, v146
  v_cvt_pk_bf16_f32 v169, v148, v150
  v_cvt_pk_bf16_f32 v170, v145, v147
  v_cvt_pk_bf16_f32 v171, v149, v151
  buffer_store_dwordx4 v[168:171], v96, s[8:11], s70 offen sc1
  s_add_u32 s70, s70, 655360
  s_waitcnt lgkmcnt(0)
  v_pk_add_f32 v[152:153], v[152:153], v[108:109]
  v_pk_add_f32 v[154:155], v[154:155], v[110:111]
  v_pk_add_f32 v[156:157], v[156:157], v[112:113]
  v_pk_add_f32 v[158:159], v[158:159], v[114:115]
  v_cvt_pk_bf16_f32 v172, v152, v154
  v_cvt_pk_bf16_f32 v173, v156, v158
  v_cvt_pk_bf16_f32 v174, v153, v155
  v_cvt_pk_bf16_f32 v175, v157, v159
  buffer_store_dwordx4 v[172:175], v96, s[8:11], s70 offen sc1
  s_cmp_lg_u32 s3, 1
  s_cbranch_scc1 conv_cb2
  s_waitcnt vmcnt(4)
  v_add_f32 v82, v82, v84
  v_add_f32 v86, v86, v88
  v_add_f32 v82, v82, v86
  v_add_f32 v83, v83, v85
  v_add_f32 v87, v87, v89
  v_add_f32 v83, v83, v87
  v_and_b32 v85, 0xffff0000, v90
  v_lshlrev_b32 v84, 16, v90
  v_add_u32 v91, 162816, v91
  s_mov_b32 exec_lo, -1
  s_mov_b32 exec_hi, 0x00ffffff
  ds_write_b64 v91, v[82:83]
  ds_write_b64 v91, v[84:85] offset:448
  s_mov_b64 exec, -1
conv_cb2:
  s_mov_b32 s79, s4
mk_gemm:
  s_mov_b32 s4, s50
  s_mov_b32 s5, s51
  s_and_b32 s6, s2, 7
  s_lshr_b32 s6, s6, 1
  s_lshl_b32 s6, s6, 3
  s_lshr_b32 s64, s2, 3
  s_and_b32 s64, s64, 7
  s_add_u32 s6, s6, s64
  s_and_b32 s7, s2, 1
  s_lshl_b32 s7, s7, 2
  s_lshr_b32 s64, s2, 6
  s_add_u32 s7, s7, s64
  v_lshlrev_b32 v5, 4, v1
  v_lshrrev_b32 v6, 2, v1
  v_mul_u32_u24 v6, 224, v6
  v_and_b32 v7, 3, v1
  v_lshl_add_u32 v6, v7, 3, v6
  v_add_u32 v8, 0x10000, v6
  v_add_u32 v9, 0x20000, v6
  s_waitcnt vmcnt(4) lgkmcnt(0)
  s_barrier
  s_cmp_eq_u32 s79, -1
  s_cbranch_scc1 sequential_preLN__ssm_conv_s4__dense_activation_mish__prompt_kernel_lb_14
  s_add_u32 s68, s3, 15
  s_mul_i32 s69, s68, 110592
  s_lshl_b32 s70, s51, 5
  s_add_u32 s69, s69, s70
  s_mul_i32 s70, s68, 7168
  s_add_u32 m0, s70, 0
  s_nop 0
  buffer_load_dwordx4 v100, s[24:27], s69 offen lds
  s_add_u32 m0, s70, 1024
  s_nop 0
  buffer_load_dwordx4 v101, s[24:27], s69 offen lds
  s_add_u32 m0, s70, 2048
  s_nop 0
  buffer_load_dwordx4 v102, s[24:27], s69 offen lds
  s_add_u32 m0, s70, 3072
  s_nop 0
  buffer_load_dwordx4 v103, s[24:27], s69 offen lds
  s_add_u32 m0, s70, 4096
  s_nop 0
  buffer_load_dwordx4 v104, s[24:27], s69 offen lds
  s_add_u32 m0, s70, 5120
  s_nop 0
  buffer_load_dwordx4 v105, s[24:27], s69 offen lds
  s_add_u32 m0, s70, 6144
  s_nop 0
  buffer_load_dwordx4 v106, s[24:27], s69 offen lds
  s_mov_b32 s68, 19
  s_mul_i32 s69, s68, 110592
  s_lshl_b32 s70, s51, 5
  s_add_u32 s69, s69, s70
  s_mul_i32 s70, s68, 7168
  s_cmp_lg_u32 s3, 0
  s_cbranch_scc1 sequential_preLN__ssm_conv_s4__dense_activation_mish__prompt_kernel_lb19_15
  s_add_u32 m0, s70, 0
  s_nop 0
  buffer_load_dwordx4 v100, s[24:27], s69 offen lds
  s_add_u32 m0, s70, 4096
  s_nop 0
  buffer_load_dwordx4 v104, s[24:27], s69 offen lds
sequential_preLN__ssm_conv_s4__dense_activation_mish__prompt_kernel_lb19_15:
  s_cmp_lg_u32 s3, 1
  s_cbranch_scc1 sequential_preLN__ssm_conv_s4__dense_activation_mish__prompt_kernel_lb19_16
  s_add_u32 m0, s70, 1024
  s_nop 0
  buffer_load_dwordx4 v101, s[24:27], s69 offen lds
  s_add_u32 m0, s70, 5120
  s_nop 0
  buffer_load_dwordx4 v105, s[24:27], s69 offen lds
sequential_preLN__ssm_conv_s4__dense_activation_mish__prompt_kernel_lb19_16:
  s_cmp_lg_u32 s3, 2
  s_cbranch_scc1 sequential_preLN__ssm_conv_s4__dense_activation_mish__prompt_kernel_lb19_17
  s_add_u32 m0, s70, 2048
  s_nop 0
  buffer_load_dwordx4 v102, s[24:27], s69 offen lds
  s_add_u32 m0, s70, 6144
  s_nop 0
  buffer_load_dwordx4 v106, s[24:27], s69 offen lds
sequential_preLN__ssm_conv_s4__dense_activation_mish__prompt_kernel_lb19_17:
  s_cmp_lg_u32 s3, 3
  s_cbranch_scc1 sequential_preLN__ssm_conv_s4__dense_activation_mish__prompt_kernel_lb19_18
  s_add_u32 m0, s70, 3072
  s_nop 0
  buffer_load_dwordx4 v103, s[24:27], s69 offen lds
sequential_preLN__ssm_conv_s4__dense_activation_mish__prompt_kernel_lb19_18:
sequential_preLN__ssm_conv_s4__dense_activation_mish__prompt_kernel_lb_14:
  s_lshl_b32 s64, s4, 2
  s_add_u32 s64, s64, s3
  s_mul_i32 s74, s64, 40960
  s_add_u32 s74, s74, 2277376
  s_mul_i32 s68, s3, 14
  s_mul_i32 s76, s7, 270
  s_add_u32 s76, s76, s68
  s_lshl_b32 s76, s76, 10
  s_add_u32 s76, s76, 65536
  s_cmp_eq_u32 s3, 3
  s_cselect_b32 s77, 0x40000000, 0
  v_mov_b32 v20, 0x3f803f80
  v_mov_b32 v21, 0x3f803f80
  v_mov_b32 v22, 0x3f803f80
  v_mov_b32 v23, 0x3f803f80
  s_mov_b32 s75, s74
  s_cmp_lg_u32 s3, 0
  s_cbranch_scc1 sequential_preLN__ssm_conv_s4__dense_activation_mish__prompt_kernel_prbs_21
  v_add_u32 v12, 0, v1
  v_lshrrev_b32 v13, 3, v12
  v_lshlrev_b32 v13, 11, v13
  v_bfe_u32 v14, v12, 2, 1
  v_lshl_add_u32 v13, v14, 10, v13
  v_and_b32 v14, 3, v12
  v_lshl_add_u32 v16, v14, 8, v13
  v_add_u32 v12, 64, v1
  v_lshrrev_b32 v13, 3, v12
  v_lshlrev_b32 v13, 11, v13
  v_bfe_u32 v14, v12, 2, 1
  v_lshl_add_u32 v13, v14, 10, v13
  v_and_b32 v14, 3, v12
  v_lshl_add_u32 v17, v14, 8, v13
  v_add_u32 v12, 128, v1
  v_lshrrev_b32 v13, 3, v12
  v_lshlrev_b32 v13, 11, v13
  v_bfe_u32 v14, v12, 2, 1
  v_lshl_add_u32 v13, v14, 10, v13
  v_and_b32 v14, 3, v12
  v_lshl_add_u32 v18, v14, 8, v13
  v_min_u32 v18, 40704, v18
  s_mov_b32 s72, 4858096
  s_mov_b32 s73, 0
sequential_preLN__ssm_conv_s4__dense_activation_mish__prompt_kernel_prb_19:
  buffer_load_dword v12, v16, s[8:11], s72 offen sc1
  buffer_load_dword v13, v17, s[8:11], s72 offen sc1
  buffer_load_dword v14, v18, s[8:11], s72 offen sc1
  s_add_u32 s73, s73, 1
  s_waitcnt vmcnt(0)
  v_max3_u32 v12, v12, v13, v14
  v_cmp_eq_u32 vcc, -1, v12
  s_cmp_gt_u32 s73, 400000
  s_cbranch_scc1 sequential_preLN__ssm_conv_s4__dense_activation_mish__prompt_kernel_prbd_20
  s_cbranch_vccz sequential_preLN__ssm_conv_s4__dense_activation_mish__prompt_kernel_prbd_20
  s_sleep 6
  s_branch sequential_preLN__ssm_conv_s4__dense_activation_mish__prompt_kernel_prb_19
sequential_preLN__ssm_conv_s4__dense_activation_mish__prompt_kernel_prbd_20:
sequential_preLN__ssm_conv_s4__dense_activation_mish__prompt_kernel_prbs_21:
  s_waitcnt vmcnt(0) lgkmcnt(0)
  s_barrier
  s_mov_b32 s71, 0
g1_retry:
  s_mov_b32 s74, s75
  buffer_load_dwordx4 v[96:99], v5, s[8:11], s74 offen sc1
  buffer_load_dwordx4 v[100:103], v5, s[8:11], s74 offen offset:1024 sc1
  s_add_u32 s74, s74, 2048
  buffer_load_dwordx4 v[104:107], v5, s[8:11], s74 offen sc1
  buffer_load_dwordx4 v[108:111], v5, s[8:11], s74 offen offset:1024 sc1
  s_add_u32 s74, s74, 2048
  buffer_load_dwordx4 v[112:115], v5, s[8:11], s74 offen sc1
  buffer_load_dwordx4 v[116:119], v5, s[8:11], s74 offen offset:1024 sc1
  s_add_u32 s74, s74, 2048
  buffer_load_dwordx4 v[120:123], v5, s[8:11], s74 offen sc1
  buffer_load_dwordx4 v[124:127], v5, s[8:11], s74 offen offset:1024 sc1
  s_add_u32 s74, s74, 2048
  buffer_load_dwordx4 v[128:131], v5, s[8:11], s74 offen sc1
  buffer_load_dwordx4 v[132:135], v5, s[8:11], s74 offen offset:1024 sc1
  s_add_u32 s74, s74, 2048
  ds_read_b64_tr_b16 a[0:1], v6 offset:0
  ds_read_b64_tr_b16 a[2:3], v6 offset:3584
  ds_read_b64_tr_b16 a[4:5], v6 offset:32
  ds_read_b64_tr_b16 a[6:7], v6 offset:3616
  ds_read_b64_tr_b16 a[8:9], v6 offset:64
  ds_read_b64_tr_b16 a[10:11], v6 offset:3648
  ds_read_b64_tr_b16 a[12:13], v6 offset:96
  ds_read_b64_tr_b16 a[14:15], v6 offset:3680
  ds_read_b64_tr_b16 a[16:17], v6 offset:128
  ds_read_b64_tr_b16 a[18:19], v6 offset:3712
  ds_read_b64_tr_b16 a[20:21], v6 offset:160
  ds_read_b64_tr_b16 a[22:23], v6 offset:3744
  ds_read_b64_tr_b16 a[24:25], v6 offset:192
  ds_read_b64_tr_b16 a[26:27], v6 offset:3776
  s_waitcnt vmcnt(8)
  v_max3_u32 v10, v96, v97, v98
  v_max3_u32 v11, v99, v100, v101
  v_max3_u32 v10, v10, v102, v103
  v_swap_b32 v98, v100
  v_swap_b32 v99, v101
  s_waitcnt lgkmcnt(0)
  s_nop 0
  v_mfma_f32_16x16x32_bf16 v[24:27], a[0:3], v[96:99], 0
  ds_read_b64_tr_b16 a[28:29], v6 offset:7168
  v_mfma_f32_16x16x32_bf16 v[28:31], a[0:3], v[100:103], 0
  ds_read_b64_tr_b16 a[30:31], v6 offset:10752
  v_mfma_f32_16x16x32_bf16 v[32:35], a[4:7], v[96:99], 0
  ds_read_b64_tr_b16 a[32:33], v6 offset:7200
  v_mfma_f32_16x16x32_bf16 v[36:39], a[4:7], v[100:103], 0
  ds_read_b64_tr_b16 a[34:35], v6 offset:10784
  v_mfma_f32_16x16x32_bf16 v[40:43], a[8:11], v[96:99], 0
  ds_read_b64_tr_b16 a[36:37], v6 offset:7232
  v_mfma_f32_16x16x32_bf16 v[44:47], a[8:11], v[100:103], 0
  ds_read_b64_tr_b16 a[38:39], v6 offset:10816
  v_mfma_f32_16x16x32_bf16 v[48:51], a[12:15], v[96:99], 0
  ds_read_b64_tr_b16 a[40:41], v6 offset:7264
  v_mfma_f32_16x16x32_bf16 v[52:55], a[12:15], v[100:103], 0
  ds_read_b64_tr_b16 a[42:43], v6 offset:10848
  v_mfma_f32_16x16x32_bf16 v[56:59], a[16:19], v[96:99], 0
  ds_read_b64_tr_b16 a[44:45], v6 offset:7296
  v_mfma_f32_16x16x32_bf16 v[60:63], a[16:19], v[100:103], 0
  ds_read_b64_tr_b16 a[46:47], v6 offset:10880
  v_mfma_f32_16x16x32_bf16 v[64:67], a[20:23], v[96:99], 0
  ds_read_b64_tr_b16 a[48:49], v6 offset:7328
  v_mfma_f32_16x16x32_bf16 v[68:71], a[20:23], v[100:103], 0
  ds_read_b64_tr_b16 a[50:51], v6 offset:10912
  s_add_u32 s78, s76, 0
  buffer_load_dwordx4 a[56:59], v5, s[8:11], s78 offen offset:0 sc1
  v_mfma_f32_16x16x32_bf16 v[72:75], a[24:27], v[96:99], 0
  ds_read_b64_tr_b16 a[52:53], v6 offset:7360
  v_mfma_f32_16x16x32_bf16 v[76:79], a[24:27], v[100:103], 0
  ds_read_b64_tr_b16 a[54:55], v6 offset:10944
  buffer_load_dwordx4 a[76:79], v5, s[8:11], s78 offen offset:1024 sc1
  v_mfma_f32_16x16x32_bf16 v[80:83], v[20:23], v[96:99], 0
  s_waitcnt vmcnt(8)
  v_max3_u32 v10, v10, v104, v105
  v_max3_u32 v11, v11, v106, v107
  v_max3_u32 v10, v10, v108, v109
  v_max3_u32 v11, v11, v110, v111
  v_swap_b32 v106, v108
  v_swap_b32 v107, v109
  v_mfma_f32_16x16x32_bf16 v[88:91], v[96:99], v[96:99], 0
  buffer_load_dwordx4 v[136:139], v5, s[8:11], s74 offen sc1
  buffer_load_dwordx4 v[140:143], v5, s[8:11], s74 offen offset:1024 sc1
  s_add_u32 s74, s74, 2048
  v_mfma_f32_16x16x32_bf16 v[84:87], v[20:23], v[100:103], 0
  buffer_load_dwordx4 a[96:99], v5, s[8:11], s78 offen offset:2048 sc1
  v_mfma_f32_16x16x32_bf16 v[92:95], v[100:103], v[100:103], 0
  buffer_load_dwordx4 a[116:119], v5, s[8:11], s78 offen offset:3072 sc1
  s_waitcnt lgkmcnt(0)
  v_mfma_f32_16x16x32_bf16 v[24:27], a[28:31], v[104:107], v[24:27]
  ds_read_b64_tr_b16 a[0:1], v6 offset:14336
  v_mfma_f32_16x16x32_bf16 v[28:31], a[28:31], v[108:111], v[28:31]
  ds_read_b64_tr_b16 a[2:3], v6 offset:17920
  v_mfma_f32_16x16x32_bf16 v[32:35], a[32:35], v[104:107], v[32:35]
  ds_read_b64_tr_b16 a[4:5], v6 offset:14368
  v_mfma_f32_16x16x32_bf16 v[36:39], a[32:35], v[108:111], v[36:39]
  ds_read_b64_tr_b16 a[6:7], v6 offset:17952
  v_mfma_f32_16x16x32_bf16 v[40:43], a[36:39], v[104:107], v[40:43]
  ds_read_b64_tr_b16 a[8:9], v6 offset:14400
  v_mfma_f32_16x16x32_bf16 v[44:47], a[36:39], v[108:111], v[44:47]
  ds_read_b64_tr_b16 a[10:11], v6 offset:17984
  v_mfma_f32_16x16x32_bf16 v[48:51], a[40:43], v[104:107], v[48:51]
  ds_read_b64_tr_b16 a[12:13], v6 offset:14432
  v_mfma_f32_16x16x32_bf16 v[52:55], a[40:43], v[108:111], v[52:55]
  ds_read_b64_tr_b16 a[14:15], v6 offset:18016
  v_mfma_f32_16x16x32_bf16 v[56:59], a[44:47], v[104:107], v[56:59]
  ds_read_b64_tr_b16 a[16:17], v6 offset:14464
  v_mfma_f32_16x16x32_bf16 v[60:63], a[44:47], v[108:111], v[60:63]
  ds_read_b64_tr_b16 a[18:19], v6 offset:18048
  v_mfma_f32_16x16x32_bf16 v[64:67], a[48:51], v[104:107], v[64:67]
  ds_read_b64_tr_b16 a[20:21], v6 offset:14496
  v_mfma_f32_16x16x32_bf16 v[68:71], a[48:51], v[108:111], v[68:71]
  ds_read_b64_tr_b16 a[22:23], v6 offset:18080
  v_mfma_f32_16x16x32_bf16 v[72:75], a[52:55], v[104:107], v[72:75]
  ds_read_b64_tr_b16 a[24:25], v6 offset:14528
  v_mfma_f32_16x16x32_bf16 v[76:79], a[52:55], v[108:111], v[76:79]
  ds_read_b64_tr_b16 a[26:27], v6 offset:18112
  s_add_u32 s78, s76, 55296
  buffer_load_dwordx4 a[60:63], v5, s[8:11], s78 offen offset:0 sc1
  v_mfma_f32_16x16x32_bf16 v[80:83], v[20:23], v[104:107], v[80:83]
  s_waitcnt vmcnt(11)
  v_max3_u32 v10, v10, v112, v113
  v_max3_u32 v11, v11, v114, v115
  v_max3_u32 v10, v10, v116, v117
  v_max3_u32 v11, v11, v118, v119
  v_swap_b32 v114, v116
  v_swap_b32 v115, v117
  v_mfma_f32_16x16x32_bf16 v[88:91], v[104:107], v[104:107], v[88:91]
  buffer_load_dwordx4 v[96:99], v5, s[8:11], s74 offen sc1
  buffer_load_dwordx4 v[100:103], v5, s[8:11], s74 offen offset:1024 sc1
  s_add_u32 s74, s74, 2048
  v_mfma_f32_16x16x32_bf16 v[84:87], v[20:23], v[108:111], v[84:87]
  buffer_load_dwordx4 a[80:83], v5, s[8:11], s78 offen offset:1024 sc1
  v_mfma_f32_16x16x32_bf16 v[92:95], v[108:111], v[108:111], v[92:95]
  buffer_load_dwordx4 a[100:103], v5, s[8:11], s78 offen offset:2048 sc1
  s_waitcnt lgkmcnt(0)
  v_mfma_f32_16x16x32_bf16 v[24:27], a[0:3], v[112:115], v[24:27]
  ds_read_b64_tr_b16 a[28:29], v6 offset:21504
  v_mfma_f32_16x16x32_bf16 v[28:31], a[0:3], v[116:119], v[28:31]
  ds_read_b64_tr_b16 a[30:31], v6 offset:25088
  v_mfma_f32_16x16x32_bf16 v[32:35], a[4:7], v[112:115], v[32:35]
  ds_read_b64_tr_b16 a[32:33], v6 offset:21536
  v_mfma_f32_16x16x32_bf16 v[36:39], a[4:7], v[116:119], v[36:39]
  ds_read_b64_tr_b16 a[34:35], v6 offset:25120
  v_mfma_f32_16x16x32_bf16 v[40:43], a[8:11], v[112:115], v[40:43]
  ds_read_b64_tr_b16 a[36:37], v6 offset:21568
  v_mfma_f32_16x16x32_bf16 v[44:47], a[8:11], v[116:119], v[44:47]
  ds_read_b64_tr_b16 a[38:39], v6 offset:25152
  v_mfma_f32_16x16x32_bf16 v[48:51], a[12:15], v[112:115], v[48:51]
  ds_read_b64_tr_b16 a[40:41], v6 offset:21600
  v_mfma_f32_16x16x32_bf16 v[52:55], a[12:15], v[116:119], v[52:55]
  ds_read_b64_tr_b16 a[42:43], v6 offset:25184
  v_mfma_f32_16x16x32_bf16 v[56:59], a[16:19], v[112:115], v[56:59]
  ds_read_b64_tr_b16 a[44:45], v6 offset:21632
  v_mfma_f32_16x16x32_bf16 v[60:63], a[16:19], v[116:119], v[60:63]
  ds_read_b64_tr_b16 a[46:47], v6 offset:25216
  v_mfma_f32_16x16x32_bf16 v[64:67], a[20:23], v[112:115], v[64:67]
  ds_read_b64_tr_b16 a[48:49], v6 offset:21664
  v_mfma_f32_16x16x32_bf16 v[68:71], a[20:23], v[116:119], v[68:71]
  ds_read_b64_tr_b16 a[50:51], v6 offset:25248
  buffer_load_dwordx4 a[120:123], v5, s[8:11], s78 offen offset:3072 sc1
  v_mfma_f32_16x16x32_bf16 v[72:75], a[24:27], v[112:115], v[72:75]
  ds_read_b64_tr_b16 a[52:53], v6 offset:21696
  v_mfma_f32_16x16x32_bf16 v[76:79], a[24:27], v[116:119], v[76:79]
  ds_read_b64_tr_b16 a[54:55], v6 offset:25280
  s_add_u32 s78, s76, 110592
  buffer_load_dwordx4 a[64:67], v5, s[8:11], s78 offen offset:0 sc1
  v_mfma_f32_16x16x32_bf16 v[80:83], v[20:23], v[112:115], v[80:83]
  s_waitcnt vmcnt(15)
  v_max3_u32 v10, v10, v120, v121
  v_max3_u32 v11, v11, v122, v123
  v_max3_u32 v10, v10, v124, v125
  v_max3_u32 v11, v11, v126, v127
  v_swap_b32 v122, v124
  v_swap_b32 v123, v125
  v_mfma_f32_16x16x32_bf16 v[88:91], v[112:115], v[112:115], v[88:91]
  buffer_load_dwordx4 v[104:107], v5, s[8:11], s74 offen sc1
  buffer_load_dwordx4 v[108:111], v5, s[8:11], s74 offen offset:1024 sc1
  s_add_u32 s74, s74, 2048
  v_mfma_f32_16x16x32_bf16 v[84:87], v[20:23], v[116:119], v[84:87]
  buffer_load_dwordx4 a[84:87], v5, s[8:11], s78 offen offset:1024 sc1
  v_mfma_f32_16x16x32_bf16 v[92:95], v[116:119], v[116:119], v[92:95]
  buffer_load_dwordx4 a[104:107], v5, s[8:11], s78 offen offset:2048 sc1
  s_waitcnt lgkmcnt(0)
  v_mfma_f32_16x16x32_bf16 v[24:27], a[28:31], v[120:123], v[24:27]
  ds_read_b64_tr_b16 a[0:1], v6 offset:28672
  v_mfma_f32_16x16x32_bf16 v[28:31], a[28:31], v[124:127], v[28:31]
  ds_read_b64_tr_b16 a[2:3], v6 offset:32256
  v_mfma_f32_16x16x32_bf16 v[32:35], a[32:35], v[120:123], v[32:35]
  ds_read_b64_tr_b16 a[4:5], v6 offset:28704
  v_mfma_f32_16x16x32_bf16 v[36:39], a[32:35], v[124:127], v[36:39]
  ds_read_b64_tr_b16 a[6:7], v6 offset:32288
  v_mfma_f32_16x16x32_bf16 v[40:43], a[36:39], v[120:123], v[40:43]
  ds_read_b64_tr_b16 a[8:9], v6 offset:28736
  v_mfma_f32_16x16x32_bf16 v[44:47], a[36:39], v[124:127], v[44:47]
  ds_read_b64_tr_b16 a[10:11], v6 offset:32320
  v_mfma_f32_16x16x32_bf16 v[48:51], a[40:43], v[120:123], v[48:51]
  ds_read_b64_tr_b16 a[12:13], v6 offset:28768
  v_mfma_f32_16x16x32_bf16 v[52:55], a[40:43], v[124:127], v[52:55]
  ds_read_b64_tr_b16 a[14:15], v6 offset:32352
  v_mfma_f32_16x16x32_bf16 v[56:59], a[44:47], v[120:123], v[56:59]
  ds_read_b64_tr_b16 a[16:17], v6 offset:28800
  v_mfma_f32_16x16x32_bf16 v[60:63], a[44:47], v[124:127], v[60:63]
  ds_read_b64_tr_b16 a[18:19], v6 offset:32384
  v_mfma_f32_16x16x32_bf16 v[64:67], a[48:51], v[120:123], v[64:67]
  ds_read_b64_tr_b16 a[20:21], v6 offset:28832
  v_mfma_f32_16x16x32_bf16 v[68:71], a[48:51], v[124:127], v[68:71]
  ds_read_b64_tr_b16 a[22:23], v6 offset:32416
  v_mfma_f32_16x16x32_bf16 v[72:75], a[52:55], v[120:123], v[72:75]
  ds_read_b64_tr_b16 a[24:25], v6 offset:28864
  v_mfma_f32_16x16x32_bf16 v[76:79], a[52:55], v[124:127], v[76:79]
  ds_read_b64_tr_b16 a[26:27], v6 offset:32448
  buffer_load_dwordx4 a[124:127], v5, s[8:11], s78 offen offset:3072 sc1
  v_mfma_f32_16x16x32_bf16 v[80:83], v[20:23], v[120:123], v[80:83]
  s_waitcnt vmcnt(18)
  v_max3_u32 v10, v10, v128, v129
  v_max3_u32 v11, v11, v130, v131
  v_max3_u32 v10, v10, v132, v133
  v_max3_u32 v11, v11, v134, v135
  v_swap_b32 v130, v132
  v_swap_b32 v131, v133
  v_mfma_f32_16x16x32_bf16 v[88:91], v[120:123], v[120:123], v[88:91]
  buffer_load_dwordx4 v[112:115], v5, s[8:11], s74 offen sc1
  buffer_load_dwordx4 v[116:119], v5, s[8:11], s74 offen offset:1024 sc1
  s_add_u32 s74, s74, 2048
  v_mfma_f32_16x16x32_bf16 v[84:87], v[20:23], v[124:127], v[84:87]
  s_add_u32 s78, s76, 165888
  buffer_load_dwordx4 a[68:71], v5, s[8:11], s78 offen offset:0 sc1
  v_mfma_f32_16x16x32_bf16 v[92:95], v[124:127], v[124:127], v[92:95]
  buffer_load_dwordx4 a[88:91], v5, s[8:11], s78 offen offset:1024 sc1
  s_waitcnt lgkmcnt(0)
  v_mfma_f32_16x16x32_bf16 v[24:27], a[0:3], v[128:131], v[24:27]
  ds_read_b64_tr_b16 a[28:29], v6 offset:35840
  v_mfma_f32_16x16x32_bf16 v[28:31], a[0:3], v[132:135], v[28:31]
  ds_read_b64_tr_b16 a[30:31], v6 offset:39424
  v_mfma_f32_16x16x32_bf16 v[32:35], a[4:7], v[128:131], v[32:35]
  ds_read_b64_tr_b16 a[32:33], v6 offset:35872
  v_mfma_f32_16x16x32_bf16 v[36:39], a[4:7], v[132:135], v[36:39]
  ds_read_b64_tr_b16 a[34:35], v6 offset:39456
  v_mfma_f32_16x16x32_bf16 v[40:43], a[8:11], v[128:131], v[40:43]
  ds_read_b64_tr_b16 a[36:37], v6 offset:35904
  v_mfma_f32_16x16x32_bf16 v[44:47], a[8:11], v[132:135], v[44:47]
  ds_read_b64_tr_b16 a[38:39], v6 offset:39488
  v_mfma_f32_16x16x32_bf16 v[48:51], a[12:15], v[128:131], v[48:51]
  ds_read_b64_tr_b16 a[40:41], v6 offset:35936
  v_mfma_f32_16x16x32_bf16 v[52:55], a[12:15], v[132:135], v[52:55]
  ds_read_b64_tr_b16 a[42:43], v6 offset:39520
  v_mfma_f32_16x16x32_bf16 v[56:59], a[16:19], v[128:131], v[56:59]
  ds_read_b64_tr_b16 a[44:45], v6 offset:35968
  v_mfma_f32_16x16x32_bf16 v[60:63], a[16:19], v[132:135], v[60:63]
  ds_read_b64_tr_b16 a[46:47], v6 offset:39552
  v_mfma_f32_16x16x32_bf16 v[64:67], a[20:23], v[128:131], v[64:67]
  ds_read_b64_tr_b16 a[48:49], v6 offset:36000
  v_mfma_f32_16x16x32_bf16 v[68:71], a[20:23], v[132:135], v[68:71]
  ds_read_b64_tr_b16 a[50:51], v6 offset:39584
  buffer_load_dwordx4 a[108:111], v5, s[8:11], s78 offen offset:2048 sc1
  v_mfma_f32_16x16x32_bf16 v[72:75], a[24:27], v[128:131], v[72:75]
  ds_read_b64_tr_b16 a[52:53], v6 offset:36032
  v_mfma_f32_16x16x32_bf16 v[76:79], a[24:27], v[132:135], v[76:79]
  ds_read_b64_tr_b16 a[54:55], v6 offset:39616
  buffer_load_dwordx4 a[128:131], v5, s[8:11], s78 offen offset:3072 sc1
  v_mfma_f32_16x16x32_bf16 v[80:83], v[20:23], v[128:131], v[80:83]
  s_waitcnt vmcnt(20)
  v_max3_u32 v10, v10, v136, v137
  v_max3_u32 v11, v11, v138, v139
  v_max3_u32 v10, v10, v140, v141
  v_max3_u32 v11, v11, v142, v143
  v_swap_b32 v138, v140
  v_swap_b32 v139, v141
  v_mfma_f32_16x16x32_bf16 v[88:91], v[128:131], v[128:131], v[88:91]
  buffer_load_dwordx4 v[120:123], v5, s[8:11], s74 offen sc1
  buffer_load_dwordx4 v[124:127], v5, s[8:11], s74 offen offset:1024 sc1
  s_add_u32 s74, s74, 2048
  v_mfma_f32_16x16x32_bf16 v[84:87], v[20:23], v[132:135], v[84:87]
  s_add_u32 s78, s76, 221184
  buffer_load_dwordx4 a[72:75], v5, s[8:11], s78 offen offset:0 sc1
  v_mfma_f32_16x16x32_bf16 v[92:95], v[132:135], v[132:135], v[92:95]
  buffer_load_dwordx4 a[92:95], v5, s[8:11], s78 offen offset:1024 sc1
  s_waitcnt lgkmcnt(0)
  v_mfma_f32_16x16x32_bf16 v[24:27], a[28:31], v[136:139], v[24:27]
  ds_read_b64_tr_b16 a[0:1], v6 offset:43008
  v_mfma_f32_16x16x32_bf16 v[28:31], a[28:31], v[140:143], v[28:31]
  ds_read_b64_tr_b16 a[2:3], v6 offset:46592
  v_mfma_f32_16x16x32_bf16 v[32:35], a[32:35], v[136:139], v[32:35]
  ds_read_b64_tr_b16 a[4:5], v6 offset:43040
  v_mfma_f32_16x16x32_bf16 v[36:39], a[32:35], v[140:143], v[36:39]
  ds_read_b64_tr_b16 a[6:7], v6 offset:46624
  v_mfma_f32_16x16x32_bf16 v[40:43], a[36:39], v[136:139], v[40:43]
  ds_read_b64_tr_b16 a[8:9], v6 offset:43072
  v_mfma_f32_16x16x32_bf16 v[44:47], a[36:39], v[140:143], v[44:47]
  ds_read_b64_tr_b16 a[10:11], v6 offset:46656
  v_mfma_f32_16x16x32_bf16 v[48:51], a[40:43], v[136:139], v[48:51]
  ds_read_b64_tr_b16 a[12:13], v6 offset:43104
  v_mfma_f32_16x16x32_bf16 v[52:55], a[40:43], v[140:143], v[52:55]
  ds_read_b64_tr_b16 a[14:15], v6 offset:46688
  v_mfma_f32_16x16x32_bf16 v[56:59], a[44:47], v[136:139], v[56:59]
  ds_read_b64_tr_b16 a[16:17], v6 offset:43136
  v_mfma_f32_16x16x32_bf16 v[60:63], a[44:47], v[140:143], v[60:63]
  ds_read_b64_tr_b16 a[18:19], v6 offset:46720
  v_mfma_f32_16x16x32_bf16 v[64:67], a[48:51], v[136:139], v[64:67]
  ds_read_b64_tr_b16 a[20:21], v6 offset:43168
  v_mfma_f32_16x16x32_bf16 v[68:71], a[48:51], v[140:143], v[68:71]
  ds_read_b64_tr_b16 a[22:23], v6 offset:46752
  v_mfma_f32_16x16x32_bf16 v[72:75], a[52:55], v[136:139], v[72:75]
  ds_read_b64_tr_b16 a[24:25], v6 offset:43200
  v_mfma_f32_16x16x32_bf16 v[76:79], a[52:55], v[140:143], v[76:79]
  ds_read_b64_tr_b16 a[26:27], v6 offset:46784
  buffer_load_dwordx4 a[112:115], v5, s[8:11], s78 offen offset:2048 sc1
  v_mfma_f32_16x16x32_bf16 v[80:83], v[20:23], v[136:139], v[80:83]
  s_waitcnt vmcnt(20)
  v_max3_u32 v10, v10, v96, v97
  v_max3_u32 v11, v11, v98, v99
  v_max3_u32 v10, v10, v100, v101
  v_max3_u32 v11, v11, v102, v103
  v_swap_b32 v98, v100
  v_swap_b32 v99, v101
  v_mfma_f32_16x16x32_bf16 v[88:91], v[136:139], v[136:139], v[88:91]
  buffer_load_dwordx4 v[128:131], v5, s[8:11], s74 offen sc1
  buffer_load_dwordx4 v[132:135], v5, s[8:11], s74 offen offset:1024 sc1
  s_add_u32 s74, s74, 2048
  v_mfma_f32_16x16x32_bf16 v[84:87], v[20:23], v[140:143], v[84:87]
  buffer_load_dwordx4 a[132:135], v5, s[8:11], s78 offen offset:3072 sc1
  v_mfma_f32_16x16x32_bf16 v[92:95], v[140:143], v[140:143], v[92:95]
  s_add_u32 s78, s76, 4096
  buffer_load_dwordx4 a[136:139], v5, s[8:11], s78 offen offset:0 sc1
  s_waitcnt lgkmcnt(0)
  v_mfma_f32_16x16x32_bf16 v[24:27], a[0:3], v[96:99], v[24:27]
  ds_read_b64_tr_b16 a[28:29], v6 offset:50176
  v_mfma_f32_16x16x32_bf16 v[28:31], a[0:3], v[100:103], v[28:31]
  ds_read_b64_tr_b16 a[30:31], v6 offset:53760
  v_mfma_f32_16x16x32_bf16 v[32:35], a[4:7], v[96:99], v[32:35]
  ds_read_b64_tr_b16 a[32:33], v6 offset:50208
  v_mfma_f32_16x16x32_bf16 v[36:39], a[4:7], v[100:103], v[36:39]
  ds_read_b64_tr_b16 a[34:35], v6 offset:53792
  v_mfma_f32_16x16x32_bf16 v[40:43], a[8:11], v[96:99], v[40:43]
  ds_read_b64_tr_b16 a[36:37], v6 offset:50240
  v_mfma_f32_16x16x32_bf16 v[44:47], a[8:11], v[100:103], v[44:47]
  ds_read_b64_tr_b16 a[38:39], v6 offset:53824
  v_mfma_f32_16x16x32_bf16 v[48:51], a[12:15], v[96:99], v[48:51]
  ds_read_b64_tr_b16 a[40:41], v6 offset:50272
  v_mfma_f32_16x16x32_bf16 v[52:55], a[12:15], v[100:103], v[52:55]
  ds_read_b64_tr_b16 a[42:43], v6 offset:53856
  v_mfma_f32_16x16x32_bf16 v[56:59], a[16:19], v[96:99], v[56:59]
  ds_read_b64_tr_b16 a[44:45], v6 offset:50304
  v_mfma_f32_16x16x32_bf16 v[60:63], a[16:19], v[100:103], v[60:63]
  ds_read_b64_tr_b16 a[46:47], v6 offset:53888
  v_mfma_f32_16x16x32_bf16 v[64:67], a[20:23], v[96:99], v[64:67]
  ds_read_b64_tr_b16 a[48:49], v6 offset:50336
  v_mfma_f32_16x16x32_bf16 v[68:71], a[20:23], v[100:103], v[68:71]
  ds_read_b64_tr_b16 a[50:51], v6 offset:53920
  buffer_load_dwordx4 a[156:159], v5, s[8:11], s78 offen offset:1024 sc1
  v_mfma_f32_16x16x32_bf16 v[72:75], a[24:27], v[96:99], v[72:75]
  ds_read_b64_tr_b16 a[52:53], v6 offset:50368
  v_mfma_f32_16x16x32_bf16 v[76:79], a[24:27], v[100:103], v[76:79]
  ds_read_b64_tr_b16 a[54:55], v6 offset:53952
  buffer_load_dwordx4 a[176:179], v5, s[8:11], s78 offen offset:2048 sc1
  v_mfma_f32_16x16x32_bf16 v[80:83], v[20:23], v[96:99], v[80:83]
  s_waitcnt vmcnt(20)
  v_max3_u32 v10, v10, v104, v105
  v_max3_u32 v11, v11, v106, v107
  v_max3_u32 v10, v10, v108, v109
  v_max3_u32 v11, v11, v110, v111
  v_swap_b32 v106, v108
  v_swap_b32 v107, v109
  v_mfma_f32_16x16x32_bf16 v[88:91], v[96:99], v[96:99], v[88:91]
  buffer_load_dwordx4 v[136:139], v5, s[8:11], s74 offen sc1
  buffer_load_dwordx4 v[140:143], v5, s[8:11], s74 offen offset:1024 sc1
  s_add_u32 s74, s74, 2048
  v_mfma_f32_16x16x32_bf16 v[84:87], v[20:23], v[100:103], v[84:87]
  buffer_load_dwordx4 a[196:199], v5, s[8:11], s78 offen offset:3072 sc1
  v_mfma_f32_16x16x32_bf16 v[92:95], v[100:103], v[100:103], v[92:95]
  s_add_u32 s78, s76, 59392
  buffer_load_dwordx4 a[140:143], v5, s[8:11], s78 offen offset:0 sc1
  s_waitcnt lgkmcnt(0)
  v_mfma_f32_16x16x32_bf16 v[24:27], a[28:31], v[104:107], v[24:27]
  ds_read_b64_tr_b16 a[0:1], v6 offset:57344
  v_mfma_f32_16x16x32_bf16 v[28:31], a[28:31], v[108:111], v[28:31]
  ds_read_b64_tr_b16 a[2:3], v6 offset:60928
  v_mfma_f32_16x16x32_bf16 v[32:35], a[32:35], v[104:107], v[32:35]
  ds_read_b64_tr_b16 a[4:5], v6 offset:57376
  v_mfma_f32_16x16x32_bf16 v[36:39], a[32:35], v[108:111], v[36:39]
  ds_read_b64_tr_b16 a[6:7], v6 offset:60960
  v_mfma_f32_16x16x32_bf16 v[40:43], a[36:39], v[104:107], v[40:43]
  ds_read_b64_tr_b16 a[8:9], v6 offset:57408
  v_mfma_f32_16x16x32_bf16 v[44:47], a[36:39], v[108:111], v[44:47]
  ds_read_b64_tr_b16 a[10:11], v6 offset:60992
  v_mfma_f32_16x16x32_bf16 v[48:51], a[40:43], v[104:107], v[48:51]
  ds_read_b64_tr_b16 a[12:13], v6 offset:57440
  v_mfma_f32_16x16x32_bf16 v[52:55], a[40:43], v[108:111], v[52:55]
  ds_read_b64_tr_b16 a[14:15], v6 offset:61024
  v_mfma_f32_16x16x32_bf16 v[56:59], a[44:47], v[104:107], v[56:59]
  ds_read_b64_tr_b16 a[16:17], v6 offset:57472
  v_mfma_f32_16x16x32_bf16 v[60:63], a[44:47], v[108:111], v[60:63]
  ds_read_b64_tr_b16 a[18:19], v6 offset:61056
  v_mfma_f32_16x16x32_bf16 v[64:67], a[48:51], v[104:107], v[64:67]
  ds_read_b64_tr_b16 a[20:21], v6 offset:57504
  v_mfma_f32_16x16x32_bf16 v[68:71], a[48:51], v[108:111], v[68:71]
  ds_read_b64_tr_b16 a[22:23], v6 offset:61088
  v_mfma_f32_16x16x32_bf16 v[72:75], a[52:55], v[104:107], v[72:75]
  ds_read_b64_tr_b16 a[24:25], v6 offset:57536
  v_mfma_f32_16x16x32_bf16 v[76:79], a[52:55], v[108:111], v[76:79]
  ds_read_b64_tr_b16 a[26:27], v6 offset:61120
  buffer_load_dwordx4 a[160:163], v5, s[8:11], s78 offen offset:1024 sc1
  v_mfma_f32_16x16x32_bf16 v[80:83], v[20:23], v[104:107], v[80:83]
  s_waitcnt vmcnt(20)
  v_max3_u32 v10, v10, v112, v113
  v_max3_u32 v11, v11, v114, v115
  v_max3_u32 v10, v10, v116, v117
  v_max3_u32 v11, v11, v118, v119
  v_swap_b32 v114, v116
  v_swap_b32 v115, v117
  v_mfma_f32_16x16x32_bf16 v[88:91], v[104:107], v[104:107], v[88:91]
  buffer_load_dwordx4 v[96:99], v5, s[8:11], s74 offen sc1
  buffer_load_dwordx4 v[100:103], v5, s[8:11], s74 offen offset:1024 sc1
  s_add_u32 s74, s74, 2048
  v_mfma_f32_16x16x32_bf16 v[84:87], v[20:23], v[108:111], v[84:87]
  buffer_load_dwordx4 a[180:183], v5, s[8:11], s78 offen offset:2048 sc1
  v_mfma_f32_16x16x32_bf16 v[92:95], v[108:111], v[108:111], v[92:95]
  buffer_load_dwordx4 a[200:203], v5, s[8:11], s78 offen offset:3072 sc1
  s_waitcnt lgkmcnt(0)
  v_mfma_f32_16x16x32_bf16 v[24:27], a[0:3], v[112:115], v[24:27]
  ds_read_b64_tr_b16 a[28:29], v6 offset:64512
  v_mfma_f32_16x16x32_bf16 v[28:31], a[0:3], v[116:119], v[28:31]
  ds_read_b64_tr_b16 a[30:31], v8 offset:2560
  v_mfma_f32_16x16x32_bf16 v[32:35], a[4:7], v[112:115], v[32:35]
  ds_read_b64_tr_b16 a[32:33], v6 offset:64544
  v_mfma_f32_16x16x32_bf16 v[36:39], a[4:7], v[116:119], v[36:39]
  ds_read_b64_tr_b16 a[34:35], v8 offset:2592
  v_mfma_f32_16x16x32_bf16 v[40:43], a[8:11], v[112:115], v[40:43]
  ds_read_b64_tr_b16 a[36:37], v6 offset:64576
  v_mfma_f32_16x16x32_bf16 v[44:47], a[8:11], v[116:119], v[44:47]
  ds_read_b64_tr_b16 a[38:39], v8 offset:2624
  v_mfma_f32_16x16x32_bf16 v[48:51], a[12:15], v[112:115], v[48:51]
  ds_read_b64_tr_b16 a[40:41], v6 offset:64608
  v_mfma_f32_16x16x32_bf16 v[52:55], a[12:15], v[116:119], v[52:55]
  ds_read_b64_tr_b16 a[42:43], v8 offset:2656
  v_mfma_f32_16x16x32_bf16 v[56:59], a[16:19], v[112:115], v[56:59]
  ds_read_b64_tr_b16 a[44:45], v6 offset:64640
  v_mfma_f32_16x16x32_bf16 v[60:63], a[16:19], v[116:119], v[60:63]
  ds_read_b64_tr_b16 a[46:47], v8 offset:2688
  v_mfma_f32_16x16x32_bf16 v[64:67], a[20:23], v[112:115], v[64:67]
  ds_read_b64_tr_b16 a[48:49], v6 offset:64672
  v_mfma_f32_16x16x32_bf16 v[68:71], a[20:23], v[116:119], v[68:71]
  ds_read_b64_tr_b16 a[50:51], v8 offset:2720
  s_add_u32 s78, s76, 114688
  buffer_load_dwordx4 a[144:147], v5, s[8:11], s78 offen offset:0 sc1
  v_mfma_f32_16x16x32_bf16 v[72:75], a[24:27], v[112:115], v[72:75]
  ds_read_b64_tr_b16 a[52:53], v6 offset:64704
  v_mfma_f32_16x16x32_bf16 v[76:79], a[24:27], v[116:119], v[76:79]
  ds_read_b64_tr_b16 a[54:55], v8 offset:2752
  buffer_load_dwordx4 a[164:167], v5, s[8:11], s78 offen offset:1024 sc1
  v_mfma_f32_16x16x32_bf16 v[80:83], v[20:23], v[112:115], v[80:83]
  s_waitcnt vmcnt(20)
  v_max3_u32 v10, v10, v120, v121
  v_max3_u32 v11, v11, v122, v123
  v_max3_u32 v10, v10, v124, v125
  v_max3_u32 v11, v11, v126, v127
  v_swap_b32 v122, v124
  v_swap_b32 v123, v125
  v_mfma_f32_16x16x32_bf16 v[88:91], v[112:115], v[112:115], v[88:91]
  buffer_load_dwordx4 v[104:107], v5, s[8:11], s74 offen sc1
  buffer_load_dwordx4 v[108:111], v5, s[8:11], s74 offen offset:1024 sc1
  s_add_u32 s74, s74, 2048
  v_mfma_f32_16x16x32_bf16 v[84:87], v[20:23], v[116:119], v[84:87]
  buffer_load_dwordx4 a[184:187], v5, s[8:11], s78 offen offset:2048 sc1
  v_mfma_f32_16x16x32_bf16 v[92:95], v[116:119], v[116:119], v[92:95]
  buffer_load_dwordx4 a[204:207], v5, s[8:11], s78 offen offset:3072 sc1
  s_waitcnt lgkmcnt(0)
  v_mfma_f32_16x16x32_bf16 v[24:27], a[28:31], v[120:123], v[24:27]
  ds_read_b64_tr_b16 a[0:1], v8 offset:6144
  v_mfma_f32_16x16x32_bf16 v[28:31], a[28:31], v[124:127], v[28:31]
  ds_read_b64_tr_b16 a[2:3], v8 offset:9728
  v_mfma_f32_16x16x32_bf16 v[32:35], a[32:35], v[120:123], v[32:35]
  ds_read_b64_tr_b16 a[4:5], v8 offset:6176
  v_mfma_f32_16x16x32_bf16 v[36:39], a[32:35], v[124:127], v[36:39]
  ds_read_b64_tr_b16 a[6:7], v8 offset:9760
  v_mfma_f32_16x16x32_bf16 v[40:43], a[36:39], v[120:123], v[40:43]
  ds_read_b64_tr_b16 a[8:9], v8 offset:6208
  v_mfma_f32_16x16x32_bf16 v[44:47], a[36:39], v[124:127], v[44:47]
  ds_read_b64_tr_b16 a[10:11], v8 offset:9792
  v_mfma_f32_16x16x32_bf16 v[48:51], a[40:43], v[120:123], v[48:51]
  ds_read_b64_tr_b16 a[12:13], v8 offset:6240
  v_mfma_f32_16x16x32_bf16 v[52:55], a[40:43], v[124:127], v[52:55]
  ds_read_b64_tr_b16 a[14:15], v8 offset:9824
  v_mfma_f32_16x16x32_bf16 v[56:59], a[44:47], v[120:123], v[56:59]
  ds_read_b64_tr_b16 a[16:17], v8 offset:6272
  v_mfma_f32_16x16x32_bf16 v[60:63], a[44:47], v[124:127], v[60:63]
  ds_read_b64_tr_b16 a[18:19], v8 offset:9856
  v_mfma_f32_16x16x32_bf16 v[64:67], a[48:51], v[120:123], v[64:67]
  ds_read_b64_tr_b16 a[20:21], v8 offset:6304
  v_mfma_f32_16x16x32_bf16 v[68:71], a[48:51], v[124:127], v[68:71]
  ds_read_b64_tr_b16 a[22:23], v8 offset:9888
  v_mfma_f32_16x16x32_bf16 v[72:75], a[52:55], v[120:123], v[72:75]
  ds_read_b64_tr_b16 a[24:25], v8 offset:6336
  v_mfma_f32_16x16x32_bf16 v[76:79], a[52:55], v[124:127], v[76:79]
  ds_read_b64_tr_b16 a[26:27], v8 offset:9920
  s_add_u32 s78, s76, 169984
  buffer_load_dwordx4 a[148:151], v5, s[8:11], s78 offen offset:0 sc1
  v_mfma_f32_16x16x32_bf16 v[80:83], v[20:23], v[120:123], v[80:83]
  s_waitcnt vmcnt(20)
  v_max3_u32 v10, v10, v128, v129
  v_max3_u32 v11, v11, v130, v131
  v_max3_u32 v10, v10, v132, v133
  v_max3_u32 v11, v11, v134, v135
  v_swap_b32 v130, v132
  v_swap_b32 v131, v133
  v_mfma_f32_16x16x32_bf16 v[88:91], v[120:123], v[120:123], v[88:91]
  buffer_load_dwordx4 v[112:115], v5, s[8:11], s74 offen sc1
  buffer_load_dwordx4 v[116:119], v5, s[8:11], s74 offen offset:1024 sc1
  s_add_u32 s74, s74, 2048
  v_mfma_f32_16x16x32_bf16 v[84:87], v[20:23], v[124:127], v[84:87]
  buffer_load_dwordx4 a[168:171], v5, s[8:11], s78 offen offset:1024 sc1
  v_mfma_f32_16x16x32_bf16 v[92:95], v[124:127], v[124:127], v[92:95]
  buffer_load_dwordx4 a[188:191], v5, s[8:11], s78 offen offset:2048 sc1
  s_waitcnt lgkmcnt(0)
  v_mfma_f32_16x16x32_bf16 v[24:27], a[0:3], v[128:131], v[24:27]
  ds_read_b64_tr_b16 a[28:29], v8 offset:13312
  v_mfma_f32_16x16x32_bf16 v[28:31], a[0:3], v[132:135], v[28:31]
  ds_read_b64_tr_b16 a[30:31], v8 offset:16896
  v_mfma_f32_16x16x32_bf16 v[32:35], a[4:7], v[128:131], v[32:35]
  ds_read_b64_tr_b16 a[32:33], v8 offset:13344
  v_mfma_f32_16x16x32_bf16 v[36:39], a[4:7], v[132:135], v[36:39]
  ds_read_b64_tr_b16 a[34:35], v8 offset:16928
  v_mfma_f32_16x16x32_bf16 v[40:43], a[8:11], v[128:131], v[40:43]
  ds_read_b64_tr_b16 a[36:37], v8 offset:13376
  v_mfma_f32_16x16x32_bf16 v[44:47], a[8:11], v[132:135], v[44:47]
  ds_read_b64_tr_b16 a[38:39], v8 offset:16960
  v_mfma_f32_16x16x32_bf16 v[48:51], a[12:15], v[128:131], v[48:51]
  ds_read_b64_tr_b16 a[40:41], v8 offset:13408
  v_mfma_f32_16x16x32_bf16 v[52:55], a[12:15], v[132:135], v[52:55]
  ds_read_b64_tr_b16 a[42:43], v8 offset:16992
  v_mfma_f32_16x16x32_bf16 v[56:59], a[16:19], v[128:131], v[56:59]
  ds_read_b64_tr_b16 a[44:45], v8 offset:13440
  v_mfma_f32_16x16x32_bf16 v[60:63], a[16:19], v[132:135], v[60:63]
  ds_read_b64_tr_b16 a[46:47], v8 offset:17024
  v_mfma_f32_16x16x32_bf16 v[64:67], a[20:23], v[128:131], v[64:67]
  ds_read_b64_tr_b16 a[48:49], v8 offset:13472
  v_mfma_f32_16x16x32_bf16 v[68:71], a[20:23], v[132:135], v[68:71]
  ds_read_b64_tr_b16 a[50:51], v8 offset:17056
  buffer_load_dwordx4 a[208:211], v5, s[8:11], s78 offen offset:3072 sc1
  v_mfma_f32_16x16x32_bf16 v[72:75], a[24:27], v[128:131], v[72:75]
  ds_read_b64_tr_b16 a[52:53], v8 offset:13504
  v_mfma_f32_16x16x32_bf16 v[76:79], a[24:27], v[132:135], v[76:79]
  ds_read_b64_tr_b16 a[54:55], v8 offset:17088
  s_add_u32 s78, s76, 225280
  buffer_load_dwordx4 a[152:155], v5, s[8:11], s78 offen offset:0 sc1
  v_mfma_f32_16x16x32_bf16 v[80:83], v[20:23], v[128:131], v[80:83]
  s_waitcnt vmcnt(20)
  v_max3_u32 v10, v10, v136, v137
  v_max3_u32 v11, v11, v138, v139
  v_max3_u32 v10, v10, v140, v141
  v_max3_u32 v11, v11, v142, v143
  v_swap_b32 v138, v140
  v_swap_b32 v139, v141
  v_mfma_f32_16x16x32_bf16 v[88:91], v[128:131], v[128:131], v[88:91]
  buffer_load_dwordx4 v[120:123], v5, s[8:11], s74 offen sc1
  buffer_load_dwordx4 v[124:127], v5, s[8:11], s74 offen offset:1024 sc1
  s_add_u32 s74, s74, 2048
  v_mfma_f32_16x16x32_bf16 v[84:87], v[20:23], v[132:135], v[84:87]
  buffer_load_dwordx4 a[172:175], v5, s[8:11], s78 offen offset:1024 sc1
  v_mfma_f32_16x16x32_bf16 v[92:95], v[132:135], v[132:135], v[92:95]
  buffer_load_dwordx4 a[192:195], v5, s[8:11], s78 offen offset:2048 sc1
  s_waitcnt lgkmcnt(0)
  v_mfma_f32_16x16x32_bf16 v[24:27], a[28:31], v[136:139], v[24:27]
  ds_read_b64_tr_b16 a[0:1], v8 offset:20480
  v_mfma_f32_16x16x32_bf16 v[28:31], a[28:31], v[140:143], v[28:31]
  ds_read_b64_tr_b16 a[2:3], v8 offset:24064
  v_mfma_f32_16x16x32_bf16 v[32:35], a[32:35], v[136:139], v[32:35]
  ds_read_b64_tr_b16 a[4:5], v8 offset:20512
  v_mfma_f32_16x16x32_bf16 v[36:39], a[32:35], v[140:143], v[36:39]
  ds_read_b64_tr_b16 a[6:7], v8 offset:24096
  v_mfma_f32_16x16x32_bf16 v[40:43], a[36:39], v[136:139], v[40:43]
  ds_read_b64_tr_b16 a[8:9], v8 offset:20544
  v_mfma_f32_16x16x32_bf16 v[44:47], a[36:39], v[140:143], v[44:47]
  ds_read_b64_tr_b16 a[10:11], v8 offset:24128
  v_mfma_f32_16x16x32_bf16 v[48:51], a[40:43], v[136:139], v[48:51]
  ds_read_b64_tr_b16 a[12:13], v8 offset:20576
  v_mfma_f32_16x16x32_bf16 v[52:55], a[40:43], v[140:143], v[52:55]
  ds_read_b64_tr_b16 a[14:15], v8 offset:24160
  v_mfma_f32_16x16x32_bf16 v[56:59], a[44:47], v[136:139], v[56:59]
  ds_read_b64_tr_b16 a[16:17], v8 offset:20608
  v_mfma_f32_16x16x32_bf16 v[60:63], a[44:47], v[140:143], v[60:63]
  ds_read_b64_tr_b16 a[18:19], v8 offset:24192
  v_mfma_f32_16x16x32_bf16 v[64:67], a[48:51], v[136:139], v[64:67]
  ds_read_b64_tr_b16 a[20:21], v8 offset:20640
  v_mfma_f32_16x16x32_bf16 v[68:71], a[48:51], v[140:143], v[68:71]
  ds_read_b64_tr_b16 a[22:23], v8 offset:24224
  v_mfma_f32_16x16x32_bf16 v[72:75], a[52:55], v[136:139], v[72:75]
  ds_read_b64_tr_b16 a[24:25], v8 offset:20672
  v_mfma_f32_16x16x32_bf16 v[76:79], a[52:55], v[140:143], v[76:79]
  ds_read_b64_tr_b16 a[26:27], v8 offset:24256
  buffer_load_dwordx4 a[212:215], v5, s[8:11], s78 offen offset:3072 sc1
  v_mfma_f32_16x16x32_bf16 v[80:83], v[20:23], v[136:139], v[80:83]
  s_waitcnt vmcnt(20)
  v_max3_u32 v10, v10, v96, v97
  v_max3_u32 v11, v11, v98, v99
  v_max3_u32 v10, v10, v100, v101
  v_max3_u32 v11, v11, v102, v103
  v_swap_b32 v98, v100
  v_swap_b32 v99, v101
  v_mfma_f32_16x16x32_bf16 v[88:91], v[136:139], v[136:139], v[88:91]
  buffer_load_dwordx4 v[128:131], v5, s[8:11], s74 offen sc1
  buffer_load_dwordx4 v[132:135], v5, s[8:11], s74 offen offset:1024 sc1
  s_add_u32 s74, s74, 2048
  v_mfma_f32_16x16x32_bf16 v[84:87], v[20:23], v[140:143], v[84:87]
  s_add_u32 s78, s76, 8192
  buffer_load_dwordx4 a[216:219], v5, s[8:11], s78 offen offset:0 sc1
  v_mfma_f32_16x16x32_bf16 v[92:95], v[140:143], v[140:143], v[92:95]
  buffer_load_dwordx4 a[236:239], v5, s[8:11], s78 offen offset:1024 sc1
  s_waitcnt lgkmcnt(0)
  v_mfma_f32_16x16x32_bf16 v[24:27], a[0:3], v[96:99], v[24:27]
  ds_read_b64_tr_b16 a[28:29], v8 offset:27648
  v_mfma_f32_16x16x32_bf16 v[28:31], a[0:3], v[100:103], v[28:31]
  ds_read_b64_tr_b16 a[30:31], v8 offset:31232
  v_mfma_f32_16x16x32_bf16 v[32:35], a[4:7], v[96:99], v[32:35]
  ds_read_b64_tr_b16 a[32:33], v8 offset:27680
  v_mfma_f32_16x16x32_bf16 v[36:39], a[4:7], v[100:103], v[36:39]
  ds_read_b64_tr_b16 a[34:35], v8 offset:31264
  v_mfma_f32_16x16x32_bf16 v[40:43], a[8:11], v[96:99], v[40:43]
  ds_read_b64_tr_b16 a[36:37], v8 offset:27712
  v_mfma_f32_16x16x32_bf16 v[44:47], a[8:11], v[100:103], v[44:47]
  ds_read_b64_tr_b16 a[38:39], v8 offset:31296
  v_mfma_f32_16x16x32_bf16 v[48:51], a[12:15], v[96:99], v[48:51]
  ds_read_b64_tr_b16 a[40:41], v8 offset:27744
  v_mfma_f32_16x16x32_bf16 v[52:55], a[12:15], v[100:103], v[52:55]
  ds_read_b64_tr_b16 a[42:43], v8 offset:31328
  v_mfma_f32_16x16x32_bf16 v[56:59], a[16:19], v[96:99], v[56:59]
  ds_read_b64_tr_b16 a[44:45], v8 offset:27776
  v_mfma_f32_16x16x32_bf16 v[60:63], a[16:19], v[100:103], v[60:63]
  ds_read_b64_tr_b16 a[46:47], v8 offset:31360
  v_mfma_f32_16x16x32_bf16 v[64:67], a[20:23], v[96:99], v[64:67]
  ds_read_b64_tr_b16 a[48:49], v8 offset:27808
  v_mfma_f32_16x16x32_bf16 v[68:71], a[20:23], v[100:103], v[68:71]
  ds_read_b64_tr_b16 a[50:51], v8 offset:31392
  buffer_load_dwordx4 v[176:179], v5, s[8:11], s78 offen offset:2048 sc1
  v_mfma_f32_16x16x32_bf16 v[72:75], a[24:27], v[96:99], v[72:75]
  ds_read_b64_tr_b16 a[52:53], v8 offset:27840
  v_mfma_f32_16x16x32_bf16 v[76:79], a[24:27], v[100:103], v[76:79]
  ds_read_b64_tr_b16 a[54:55], v8 offset:31424
  buffer_load_dwordx4 v[196:199], v5, s[8:11], s78 offen offset:3072 sc1
  v_mfma_f32_16x16x32_bf16 v[80:83], v[20:23], v[96:99], v[80:83]
  s_waitcnt vmcnt(20)
  v_max3_u32 v10, v10, v104, v105
  v_max3_u32 v11, v11, v106, v107
  v_max3_u32 v10, v10, v108, v109
  v_max3_u32 v11, v11, v110, v111
  v_swap_b32 v106, v108
  v_swap_b32 v107, v109
  v_mfma_f32_16x16x32_bf16 v[88:91], v[96:99], v[96:99], v[88:91]
  buffer_load_dwordx4 v[136:139], v5, s[8:11], s74 offen sc1
  buffer_load_dwordx4 v[140:143], v5, s[8:11], s74 offen offset:1024 sc1
  s_add_u32 s74, s74, 2048
  v_mfma_f32_16x16x32_bf16 v[84:87], v[20:23], v[100:103], v[84:87]
  s_add_u32 s78, s76, 63488
  buffer_load_dwordx4 a[220:223], v5, s[8:11], s78 offen offset:0 sc1
  v_mfma_f32_16x16x32_bf16 v[92:95], v[100:103], v[100:103], v[92:95]
  buffer_load_dwordx4 a[240:243], v5, s[8:11], s78 offen offset:1024 sc1
  s_waitcnt lgkmcnt(0)
  v_mfma_f32_16x16x32_bf16 v[24:27], a[28:31], v[104:107], v[24:27]
  ds_read_b64_tr_b16 a[0:1], v8 offset:34816
  v_mfma_f32_16x16x32_bf16 v[28:31], a[28:31], v[108:111], v[28:31]
  ds_read_b64_tr_b16 a[2:3], v8 offset:38400
  v_mfma_f32_16x16x32_bf16 v[32:35], a[32:35], v[104:107], v[32:35]
  ds_read_b64_tr_b16 a[4:5], v8 offset:34848
  v_mfma_f32_16x16x32_bf16 v[36:39], a[32:35], v[108:111], v[36:39]
  ds_read_b64_tr_b16 a[6:7], v8 offset:38432
  v_mfma_f32_16x16x32_bf16 v[40:43], a[36:39], v[104:107], v[40:43]
  ds_read_b64_tr_b16 a[8:9], v8 offset:34880
  v_mfma_f32_16x16x32_bf16 v[44:47], a[36:39], v[108:111], v[44:47]
  ds_read_b64_tr_b16 a[10:11], v8 offset:38464
  v_mfma_f32_16x16x32_bf16 v[48:51], a[40:43], v[104:107], v[48:51]
  ds_read_b64_tr_b16 a[12:13], v8 offset:34912
  v_mfma_f32_16x16x32_bf16 v[52:55], a[40:43], v[108:111], v[52:55]
  ds_read_b64_tr_b16 a[14:15], v8 offset:38496
  v_mfma_f32_16x16x32_bf16 v[56:59], a[44:47], v[104:107], v[56:59]
  ds_read_b64_tr_b16 a[16:17], v8 offset:34944
  v_mfma_f32_16x16x32_bf16 v[60:63], a[44:47], v[108:111], v[60:63]
  ds_read_b64_tr_b16 a[18:19], v8 offset:38528
  v_mfma_f32_16x16x32_bf16 v[64:67], a[48:51], v[104:107], v[64:67]
  ds_read_b64_tr_b16 a[20:21], v8 offset:34976
  v_mfma_f32_16x16x32_bf16 v[68:71], a[48:51], v[108:111], v[68:71]
  ds_read_b64_tr_b16 a[22:23], v8 offset:38560
  v_mfma_f32_16x16x32_bf16 v[72:75], a[52:55], v[104:107], v[72:75]
  ds_read_b64_tr_b16 a[24:25], v8 offset:35008
  v_mfma_f32_16x16x32_bf16 v[76:79], a[52:55], v[108:111], v[76:79]
  ds_read_b64_tr_b16 a[26:27], v8 offset:38592
  buffer_load_dwordx4 v[180:183], v5, s[8:11], s78 offen offset:2048 sc1
  v_mfma_f32_16x16x32_bf16 v[80:83], v[20:23], v[104:107], v[80:83]
  s_waitcnt vmcnt(20)
  v_max3_u32 v10, v10, v112, v113
  v_max3_u32 v11, v11, v114, v115
  v_max3_u32 v10, v10, v116, v117
  v_max3_u32 v11, v11, v118, v119
  v_swap_b32 v114, v116
  v_swap_b32 v115, v117
  v_mfma_f32_16x16x32_bf16 v[88:91], v[104:107], v[104:107], v[88:91]
  buffer_load_dwordx4 v[96:99], v5, s[8:11], s74 offen sc1
  buffer_load_dwordx4 v[100:103], v5, s[8:11], s74 offen offset:1024 sc1
  s_add_u32 s74, s74, 2048
  v_mfma_f32_16x16x32_bf16 v[84:87], v[20:23], v[108:111], v[84:87]
  buffer_load_dwordx4 v[200:203], v5, s[8:11], s78 offen offset:3072 sc1
  v_mfma_f32_16x16x32_bf16 v[92:95], v[108:111], v[108:111], v[92:95]
  s_add_u32 s78, s76, 118784
  buffer_load_dwordx4 a[224:227], v5, s[8:11], s78 offen offset:0 sc1
  s_waitcnt lgkmcnt(0)
  v_mfma_f32_16x16x32_bf16 v[24:27], a[0:3], v[112:115], v[24:27]
  ds_read_b64_tr_b16 a[28:29], v8 offset:41984
  v_mfma_f32_16x16x32_bf16 v[28:31], a[0:3], v[116:119], v[28:31]
  ds_read_b64_tr_b16 a[30:31], v8 offset:45568
  v_mfma_f32_16x16x32_bf16 v[32:35], a[4:7], v[112:115], v[32:35]
  ds_read_b64_tr_b16 a[32:33], v8 offset:42016
  v_mfma_f32_16x16x32_bf16 v[36:39], a[4:7], v[116:119], v[36:39]
  ds_read_b64_tr_b16 a[34:35], v8 offset:45600
  v_mfma_f32_16x16x32_bf16 v[40:43], a[8:11], v[112:115], v[40:43]
  ds_read_b64_tr_b16 a[36:37], v8 offset:42048
  v_mfma_f32_16x16x32_bf16 v[44:47], a[8:11], v[116:119], v[44:47]
  ds_read_b64_tr_b16 a[38:39], v8 offset:45632
  v_mfma_f32_16x16x32_bf16 v[48:51], a[12:15], v[112:115], v[48:51]
  ds_read_b64_tr_b16 a[40:41], v8 offset:42080
  v_mfma_f32_16x16x32_bf16 v[52:55], a[12:15], v[116:119], v[52:55]
  ds_read_b64_tr_b16 a[42:43], v8 offset:45664
  v_mfma_f32_16x16x32_bf16 v[56:59], a[16:19], v[112:115], v[56:59]
  ds_read_b64_tr_b16 a[44:45], v8 offset:42112
  v_mfma_f32_16x16x32_bf16 v[60:63], a[16:19], v[116:119], v[60:63]
  ds_read_b64_tr_b16 a[46:47], v8 offset:45696
  v_mfma_f32_16x16x32_bf16 v[64:67], a[20:23], v[112:115], v[64:67]
  ds_read_b64_tr_b16 a[48:49], v8 offset:42144
  v_mfma_f32_16x16x32_bf16 v[68:71], a[20:23], v[116:119], v[68:71]
  ds_read_b64_tr_b16 a[50:51], v8 offset:45728
  buffer_load_dwordx4 a[244:247], v5, s[8:11], s78 offen offset:1024 sc1
  v_mfma_f32_16x16x32_bf16 v[72:75], a[24:27], v[112:115], v[72:75]
  ds_read_b64_tr_b16 a[52:53], v8 offset:42176
  v_mfma_f32_16x16x32_bf16 v[76:79], a[24:27], v[116:119], v[76:79]
  ds_read_b64_tr_b16 a[54:55], v8 offset:45760
  buffer_load_dwordx4 v[184:187], v5, s[8:11], s78 offen offset:2048 sc1
  v_mfma_f32_16x16x32_bf16 v[80:83], v[20:23], v[112:115], v[80:83]
  s_waitcnt vmcnt(20)
  v_max3_u32 v10, v10, v120, v121
  v_max3_u32 v11, v11, v122, v123
  v_max3_u32 v10, v10, v124, v125
  v_max3_u32 v11, v11, v126, v127
  v_swap_b32 v122, v124
  v_swap_b32 v123, v125
  v_mfma_f32_16x16x32_bf16 v[88:91], v[112:115], v[112:115], v[88:91]
  buffer_load_dwordx4 v[104:107], v5, s[8:11], s74 offen sc1
  buffer_load_dwordx4 v[108:111], v5, s[8:11], s74 offen offset:1024 sc1
  v_mfma_f32_16x16x32_bf16 v[84:87], v[20:23], v[116:119], v[84:87]
  buffer_load_dwordx4 v[204:207], v5, s[8:11], s78 offen offset:3072 sc1
  v_mfma_f32_16x16x32_bf16 v[92:95], v[116:119], v[116:119], v[92:95]
  s_add_u32 s78, s76, 174080
  buffer_load_dwordx4 a[228:231], v5, s[8:11], s78 offen offset:0 sc1
  s_waitcnt lgkmcnt(0)
  v_mfma_f32_16x16x32_bf16 v[24:27], a[28:31], v[120:123], v[24:27]
  ds_read_b64_tr_b16 a[0:1], v8 offset:49152
  v_mfma_f32_16x16x32_bf16 v[28:31], a[28:31], v[124:127], v[28:31]
  ds_read_b64_tr_b16 a[2:3], v8 offset:52736
  v_mfma_f32_16x16x32_bf16 v[32:35], a[32:35], v[120:123], v[32:35]
  ds_read_b64_tr_b16 a[4:5], v8 offset:49184
  v_mfma_f32_16x16x32_bf16 v[36:39], a[32:35], v[124:127], v[36:39]
  ds_read_b64_tr_b16 a[6:7], v8 offset:52768
  v_mfma_f32_16x16x32_bf16 v[40:43], a[36:39], v[120:123], v[40:43]
  ds_read_b64_tr_b16 a[8:9], v8 offset:49216
  v_mfma_f32_16x16x32_bf16 v[44:47], a[36:39], v[124:127], v[44:47]
  ds_read_b64_tr_b16 a[10:11], v8 offset:52800
  v_mfma_f32_16x16x32_bf16 v[48:51], a[40:43], v[120:123], v[48:51]
  ds_read_b64_tr_b16 a[12:13], v8 offset:49248
  v_mfma_f32_16x16x32_bf16 v[52:55], a[40:43], v[124:127], v[52:55]
  ds_read_b64_tr_b16 a[14:15], v8 offset:52832
  v_mfma_f32_16x16x32_bf16 v[56:59], a[44:47], v[120:123], v[56:59]
  ds_read_b64_tr_b16 a[16:17], v8 offset:49280
  v_mfma_f32_16x16x32_bf16 v[60:63], a[44:47], v[124:127], v[60:63]
  ds_read_b64_tr_b16 a[18:19], v8 offset:52864
  v_mfma_f32_16x16x32_bf16 v[64:67], a[48:51], v[120:123], v[64:67]
  ds_read_b64_tr_b16 a[20:21], v8 offset:49312
  v_mfma_f32_16x16x32_bf16 v[68:71], a[48:51], v[124:127], v[68:71]
  ds_read_b64_tr_b16 a[22:23], v8 offset:52896
  v_mfma_f32_16x16x32_bf16 v[72:75], a[52:55], v[120:123], v[72:75]
  ds_read_b64_tr_b16 a[24:25], v8 offset:49344
  v_mfma_f32_16x16x32_bf16 v[76:79], a[52:55], v[124:127], v[76:79]
  ds_read_b64_tr_b16 a[26:27], v8 offset:52928
  buffer_load_dwordx4 a[248:251], v5, s[8:11], s78 offen offset:1024 sc1
  v_mfma_f32_16x16x32_bf16 v[80:83], v[20:23], v[120:123], v[80:83]
  s_waitcnt vmcnt(20)
  v_max3_u32 v10, v10, v128, v129
  v_max3_u32 v11, v11, v130, v131
  v_max3_u32 v10, v10, v132, v133
  v_max3_u32 v11, v11, v134, v135
  v_swap_b32 v130, v132
  v_swap_b32 v131, v133
  v_mfma_f32_16x16x32_bf16 v[88:91], v[120:123], v[120:123], v[88:91]
  v_mfma_f32_16x16x32_bf16 v[84:87], v[20:23], v[124:127], v[84:87]
  buffer_load_dwordx4 v[188:191], v5, s[8:11], s78 offen offset:2048 sc1
  v_mfma_f32_16x16x32_bf16 v[92:95], v[124:127], v[124:127], v[92:95]
  buffer_load_dwordx4 v[208:211], v5, s[8:11], s78 offen offset:3072 sc1
  s_waitcnt lgkmcnt(0)
  v_mfma_f32_16x16x32_bf16 v[24:27], a[0:3], v[128:131], v[24:27]
  ds_read_b64_tr_b16 a[28:29], v8 offset:56320
  v_mfma_f32_16x16x32_bf16 v[28:31], a[0:3], v[132:135], v[28:31]
  ds_read_b64_tr_b16 a[30:31], v8 offset:59904
  v_mfma_f32_16x16x32_bf16 v[32:35], a[4:7], v[128:131], v[32:35]
  ds_read_b64_tr_b16 a[32:33], v8 offset:56352
  v_mfma_f32_16x16x32_bf16 v[36:39], a[4:7], v[132:135], v[36:39]
  ds_read_b64_tr_b16 a[34:35], v8 offset:59936
  v_mfma_f32_16x16x32_bf16 v[40:43], a[8:11], v[128:131], v[40:43]
  ds_read_b64_tr_b16 a[36:37], v8 offset:56384
  v_mfma_f32_16x16x32_bf16 v[44:47], a[8:11], v[132:135], v[44:47]
  ds_read_b64_tr_b16 a[38:39], v8 offset:59968
  v_mfma_f32_16x16x32_bf16 v[48:51], a[12:15], v[128:131], v[48:51]
  ds_read_b64_tr_b16 a[40:41], v8 offset:56416
  v_mfma_f32_16x16x32_bf16 v[52:55], a[12:15], v[132:135], v[52:55]
  ds_read_b64_tr_b16 a[42:43], v8 offset:60000
  v_mfma_f32_16x16x32_bf16 v[56:59], a[16:19], v[128:131], v[56:59]
  ds_read_b64_tr_b16 a[44:45], v8 offset:56448
  v_mfma_f32_16x16x32_bf16 v[60:63], a[16:19], v[132:135], v[60:63]
  ds_read_b64_tr_b16 a[46:47], v8 offset:60032
  v_mfma_f32_16x16x32_bf16 v[64:67], a[20:23], v[128:131], v[64:67]
  ds_read_b64_tr_b16 a[48:49], v8 offset:56480
  v_mfma_f32_16x16x32_bf16 v[68:71], a[20:23], v[132:135], v[68:71]
  ds_read_b64_tr_b16 a[50:51], v8 offset:60064
  s_add_u32 s78, s76, 229376
  buffer_load_dwordx4 a[232:235], v5, s[8:11], s78 offen offset:0 sc1
  v_mfma_f32_16x16x32_bf16 v[72:75], a[24:27], v[128:131], v[72:75]
  ds_read_b64_tr_b16 a[52:53], v8 offset:56512
  v_mfma_f32_16x16x32_bf16 v[76:79], a[24:27], v[132:135], v[76:79]
  ds_read_b64_tr_b16 a[54:55], v8 offset:60096
  buffer_load_dwordx4 a[252:255], v5, s[8:11], s78 offen offset:1024 sc1
  v_mfma_f32_16x16x32_bf16 v[80:83], v[20:23], v[128:131], v[80:83]
  s_waitcnt vmcnt(18)
  v_max3_u32 v10, v10, v136, v137
  v_max3_u32 v11, v11, v138, v139
  v_max3_u32 v10, v10, v140, v141
  v_max3_u32 v11, v11, v142, v143
  v_swap_b32 v138, v140
  v_swap_b32 v139, v141
  v_mfma_f32_16x16x32_bf16 v[88:91], v[128:131], v[128:131], v[88:91]
  v_mfma_f32_16x16x32_bf16 v[84:87], v[20:23], v[132:135], v[84:87]
  buffer_load_dwordx4 v[192:195], v5, s[8:11], s78 offen offset:2048 sc1
  v_mfma_f32_16x16x32_bf16 v[92:95], v[132:135], v[132:135], v[92:95]
  buffer_load_dwordx4 v[212:215], v5, s[8:11], s78 offen offset:3072 sc1
  s_waitcnt lgkmcnt(0)
  v_mfma_f32_16x16x32_bf16 v[24:27], a[28:31], v[136:139], v[24:27]
  ds_read_b64_tr_b16 a[0:1], v8 offset:63488
  v_mfma_f32_16x16x32_bf16 v[28:31], a[28:31], v[140:143], v[28:31]
  ds_read_b64_tr_b16 a[2:3], v9 offset:1536
  v_mfma_f32_16x16x32_bf16 v[32:35], a[32:35], v[136:139], v[32:35]
  ds_read_b64_tr_b16 a[4:5], v8 offset:63520
  v_mfma_f32_16x16x32_bf16 v[36:39], a[32:35], v[140:143], v[36:39]
  ds_read_b64_tr_b16 a[6:7], v9 offset:1568
  v_mfma_f32_16x16x32_bf16 v[40:43], a[36:39], v[136:139], v[40:43]
  ds_read_b64_tr_b16 a[8:9], v8 offset:63552
  v_mfma_f32_16x16x32_bf16 v[44:47], a[36:39], v[140:143], v[44:47]
  ds_read_b64_tr_b16 a[10:11], v9 offset:1600
  v_mfma_f32_16x16x32_bf16 v[48:51], a[40:43], v[136:139], v[48:51]
  ds_read_b64_tr_b16 a[12:13], v8 offset:63584
  v_mfma_f32_16x16x32_bf16 v[52:55], a[40:43], v[140:143], v[52:55]
  ds_read_b64_tr_b16 a[14:15], v9 offset:1632
  v_mfma_f32_16x16x32_bf16 v[56:59], a[44:47], v[136:139], v[56:59]
  ds_read_b64_tr_b16 a[16:17], v8 offset:63616
  v_mfma_f32_16x16x32_bf16 v[60:63], a[44:47], v[140:143], v[60:63]
  ds_read_b64_tr_b16 a[18:19], v9 offset:1664
  v_mfma_f32_16x16x32_bf16 v[64:67], a[48:51], v[136:139], v[64:67]
  ds_read_b64_tr_b16 a[20:21], v8 offset:63648
  v_mfma_f32_16x16x32_bf16 v[68:71], a[48:51], v[140:143], v[68:71]
  ds_read_b64_tr_b16 a[22:23], v9 offset:1696
  v_mfma_f32_16x16x32_bf16 v[72:75], a[52:55], v[136:139], v[72:75]
  ds_read_b64_tr_b16 a[24:25], v8 offset:63680
  v_mfma_f32_16x16x32_bf16 v[76:79], a[52:55], v[140:143], v[76:79]
  ds_read_b64_tr_b16 a[26:27], v9 offset:1728
  s_add_u32 s78, s76, 12288
  s_add_u32 s78, s78, s77
  buffer_load_dwordx4 v[216:219], v5, s[8:11], s78 offen offset:0 sc1
  v_mfma_f32_16x16x32_bf16 v[80:83], v[20:23], v[136:139], v[80:83]
  s_waitcnt vmcnt(16)
  v_max3_u32 v10, v10, v96, v97
  v_max3_u32 v11, v11, v98, v99
  v_max3_u32 v10, v10, v100, v101
  v_max3_u32 v11, v11, v102, v103
  v_swap_b32 v98, v100
  v_swap_b32 v99, v101
  v_mfma_f32_16x16x32_bf16 v[88:91], v[136:139], v[136:139], v[88:91]
  v_mfma_f32_16x16x32_bf16 v[84:87], v[20:23], v[140:143], v[84:87]
  buffer_load_dwordx4 v[236:239], v5, s[8:11], s78 offen offset:1024 sc1
  v_mfma_f32_16x16x32_bf16 v[92:95], v[140:143], v[140:143], v[92:95]
  s_add_u32 s78, s76, 67584
  s_add_u32 s78, s78, s77
  buffer_load_dwordx4 v[220:223], v5, s[8:11], s78 offen offset:0 sc1
  s_waitcnt lgkmcnt(0)
  v_mfma_f32_16x16x32_bf16 v[24:27], a[0:3], v[96:99], v[24:27]
  ds_read_b64_tr_b16 a[28:29], v9 offset:5120
  v_mfma_f32_16x16x32_bf16 v[28:31], a[0:3], v[100:103], v[28:31]
  ds_read_b64_tr_b16 a[30:31], v9 offset:8704
  v_mfma_f32_16x16x32_bf16 v[32:35], a[4:7], v[96:99], v[32:35]
  ds_read_b64_tr_b16 a[32:33], v9 offset:5152
  v_mfma_f32_16x16x32_bf16 v[36:39], a[4:7], v[100:103], v[36:39]
  ds_read_b64_tr_b16 a[34:35], v9 offset:8736
  v_mfma_f32_16x16x32_bf16 v[40:43], a[8:11], v[96:99], v[40:43]
  ds_read_b64_tr_b16 a[36:37], v9 offset:5184
  v_mfma_f32_16x16x32_bf16 v[44:47], a[8:11], v[100:103], v[44:47]
  ds_read_b64_tr_b16 a[38:39], v9 offset:8768
  v_mfma_f32_16x16x32_bf16 v[48:51], a[12:15], v[96:99], v[48:51]
  ds_read_b64_tr_b16 a[40:41], v9 offset:5216
  v_mfma_f32_16x16x32_bf16 v[52:55], a[12:15], v[100:103], v[52:55]
  ds_read_b64_tr_b16 a[42:43], v9 offset:8800
  v_mfma_f32_16x16x32_bf16 v[56:59], a[16:19], v[96:99], v[56:59]
  ds_read_b64_tr_b16 a[44:45], v9 offset:5248
  v_mfma_f32_16x16x32_bf16 v[60:63], a[16:19], v[100:103], v[60:63]
  ds_read_b64_tr_b16 a[46:47], v9 offset:8832
  v_mfma_f32_16x16x32_bf16 v[64:67], a[20:23], v[96:99], v[64:67]
  ds_read_b64_tr_b16 a[48:49], v9 offset:5280
  v_mfma_f32_16x16x32_bf16 v[68:71], a[20:23], v[100:103], v[68:71]
  ds_read_b64_tr_b16 a[50:51], v9 offset:8864
  buffer_load_dwordx4 v[240:243], v5, s[8:11], s78 offen offset:1024 sc1
  v_mfma_f32_16x16x32_bf16 v[72:75], a[24:27], v[96:99], v[72:75]
  ds_read_b64_tr_b16 a[52:53], v9 offset:5312
  v_mfma_f32_16x16x32_bf16 v[76:79], a[24:27], v[100:103], v[76:79]
  ds_read_b64_tr_b16 a[54:55], v9 offset:8896
  s_add_u32 s78, s76, 122880
  s_add_u32 s78, s78, s77
  buffer_load_dwordx4 v[224:227], v5, s[8:11], s78 offen offset:0 sc1
  v_mfma_f32_16x16x32_bf16 v[80:83], v[20:23], v[96:99], v[80:83]
  s_waitcnt vmcnt(14)
  v_max3_u32 v10, v10, v104, v105
  v_max3_u32 v11, v11, v106, v107
  v_max3_u32 v10, v10, v108, v109
  v_max3_u32 v11, v11, v110, v111
  v_swap_b32 v106, v108
  v_swap_b32 v107, v109
  v_mfma_f32_16x16x32_bf16 v[88:91], v[96:99], v[96:99], v[88:91]
  v_mfma_f32_16x16x32_bf16 v[84:87], v[20:23], v[100:103], v[84:87]
  buffer_load_dwordx4 v[244:247], v5, s[8:11], s78 offen offset:1024 sc1
  v_mfma_f32_16x16x32_bf16 v[92:95], v[100:103], v[100:103], v[92:95]
  s_add_u32 s78, s76, 178176
  s_add_u32 s78, s78, s77
  buffer_load_dwordx4 v[228:231], v5, s[8:11], s78 offen offset:0 sc1
  s_waitcnt lgkmcnt(0)
  v_mfma_f32_16x16x32_bf16 v[24:27], a[28:31], v[104:107], v[24:27]
  v_mfma_f32_16x16x32_bf16 v[28:31], a[28:31], v[108:111], v[28:31]
  v_mfma_f32_16x16x32_bf16 v[32:35], a[32:35], v[104:107], v[32:35]
  v_mfma_f32_16x16x32_bf16 v[36:39], a[32:35], v[108:111], v[36:39]
  v_mfma_f32_16x16x32_bf16 v[40:43], a[36:39], v[104:107], v[40:43]
  v_mfma_f32_16x16x32_bf16 v[44:47], a[36:39], v[108:111], v[44:47]
  v_mfma_f32_16x16x32_bf16 v[48:51], a[40:43], v[104:107], v[48:51]
  v_mfma_f32_16x16x32_bf16 v[52:55], a[40:43], v[108:111], v[52:55]
  v_mfma_f32_16x16x32_bf16 v[56:59], a[44:47], v[104:107], v[56:59]
  v_mfma_f32_16x16x32_bf16 v[60:63], a[44:47], v[108:111], v[60:63]
  v_mfma_f32_16x16x32_bf16 v[64:67], a[48:51], v[104:107], v[64:67]
  v_mfma_f32_16x16x32_bf16 v[68:71], a[48:51], v[108:111], v[68:71]
  v_mfma_f32_16x16x32_bf16 v[72:75], a[52:55], v[104:107], v[72:75]
  v_mfma_f32_16x16x32_bf16 v[76:79], a[52:55], v[108:111], v[76:79]
  buffer_load_dwordx4 v[248:251], v5, s[8:11], s78 offen offset:1024 sc1
  v_mfma_f32_16x16x32_bf16 v[80:83], v[20:23], v[104:107], v[80:83]
  v_mfma_f32_16x16x32_bf16 v[88:91], v[104:107], v[104:107], v[88:91]
  v_mfma_f32_16x16x32_bf16 v[84:87], v[20:23], v[108:111], v[84:87]
  s_add_u32 s78, s76, 233472
  s_add_u32 s78, s78, s77
  buffer_load_dwordx4 v[232:235], v5, s[8:11], s78 offen offset:0 sc1
  v_mfma_f32_16x16x32_bf16 v[92:95], v[108:111], v[108:111], v[92:95]
  buffer_load_dwordx4 v[252:255], v5, s[8:11], s78 offen offset:1024 sc1
  v_max_u32 v10, v10, v11
  v_cmp_eq_u32 vcc, -1, v10
  s_cbranch_vccnz g1_redo
g1_ok:
  s_nop 1
  v_and_b32 v10, 3, v2
  v_lshrrev_b32 v11, 2, v2
  v_lshl_add_u32 v11, v11, 4, v2
  v_lshlrev_b32 v11, 2, v11
  v_cmp_eq_u32 s[64:65], 1, v10
  v_cmp_eq_u32 s[66:67], 2, v10
  v_cmp_eq_u32 s[68:69], 3, v10
  v_lshlrev_b32 v7, 4, v3
  v_add_u32 v7, 162816, v7
  ds_read_b128 v[104:107], v7
  ds_read_b128 v[108:111], v7 offset:448
  v_cndmask_b32 v88, v88, v89, s[64:65]
  v_cndmask_b32 v92, v92, v93, s[64:65]
  v_cndmask_b32 v88, v88, v90, s[66:67]
  v_cndmask_b32 v92, v92, v94, s[66:67]
  v_cndmask_b32 v88, v88, v91, s[68:69]
  v_cndmask_b32 v92, v92, v95, s[68:69]
  ds_bpermute_b32 v89, v11, v88
  ds_bpermute_b32 v93, v11, v92
  v_mul_f32 v80, 0x3acccccd, v80
  v_mul_f32 v84, 0x3acccccd, v84
  s_lshl_b32 s64, s4, 2
  s_add_u32 s64, s64, s3
  s_mul_i32 s64, s64, 110592
  s_lshl_b32 s65, s5, 10
  s_add_u32 s64, s64, s65
  s_add_u32 s64, s64, 4898816
  s_mov_b32 s70, 0x3fb8aa3b
  s_waitcnt lgkmcnt(0)
  v_mul_f32 v89, 0x3acccccd, v89
  v_mul_f32 v93, 0x3acccccd, v93
  v_fma_f32 v89, -v80, v80, v89
  v_fma_f32 v93, -v84, v84, v93
  v_max_f32 v89, 0, v89
  v_max_f32 v93, 0, v93
  v_cvt_pk_bf16_f32 v89, v89, v89
  v_cvt_pk_bf16_f32 v93, v93, v93
  v_lshlrev_b32 v89, 16, v89
  v_lshlrev_b32 v93, 16, v93
  v_add_f32 v89, 0x3727c5ac, v89
  v_add_f32 v93, 0x3727c5ac, v93
  v_cvt_pk_bf16_f32 v89, v89, v89
  v_cvt_pk_bf16_f32 v93, v93, v93
  v_lshlrev_b32 v89, 16, v89
  v_lshlrev_b32 v93, 16, v93
  v_sqrt_f32 v89, v89
  v_sqrt_f32 v93, v93
  v_cvt_pk_bf16_f32 v80, v80, v80
  v_cvt_pk_bf16_f32 v84, v84, v84
  v_cvt_pk_bf16_f32 v89, v89, v89
  v_cvt_pk_bf16_f32 v93, v93, v93
  v_lshlrev_b32 v80, 16, v80
  v_lshlrev_b32 v84, 16, v84
  v_lshlrev_b32 v89, 16, v89
  v_lshlrev_b32 v93, 16, v93
  v_rcp_f32 v96, v89
  v_rcp_f32 v100, v93
  s_nop 0
  v_mul_f32 v98, -v80, v96
  v_mul_f32 v102, -v84, v100
  ds_read_b128 v[112:115], v7 offset:64
  ds_read_b128 v[116:119], v7 offset:512
  v_pk_fma_f32 v[120:121], v[104:105], v[98:99], v[108:109] op_sel_hi:[1,0,1]
  v_pk_fma_f32 v[122:123], v[106:107], v[98:99], v[110:111] op_sel_hi:[1,0,1]
  v_pk_fma_f32 v[124:125], v[104:105], v[102:103], v[108:109] op_sel_hi:[1,0,1]
  v_pk_fma_f32 v[126:127], v[106:107], v[102:103], v[110:111] op_sel_hi:[1,0,1]
  v_pk_fma_f32 v[24:25], v[24:25], v[96:97], v[120:121] op_sel_hi:[1,0,1]
  v_pk_fma_f32 v[26:27], v[26:27], v[96:97], v[122:123] op_sel_hi:[1,0,1]
  v_pk_fma_f32 v[28:29], v[28:29], v[100:101], v[124:125] op_sel_hi:[1,0,1]
  v_pk_fma_f32 v[30:31], v[30:31], v[100:101], v[126:127] op_sel_hi:[1,0,1]
  v_pk_mul_f32 v[128:129], v[24:25], s[70:71] op_sel_hi:[1,0]
  v_pk_mul_f32 v[130:131], v[26:27], s[70:71] op_sel_hi:[1,0]
  v_pk_mul_f32 v[132:133], v[28:29], s[70:71] op_sel_hi:[1,0]
  v_pk_mul_f32 v[134:135], v[30:31], s[70:71] op_sel_hi:[1,0]
  v_exp_f32 v128, v128
  v_exp_f32 v129, v129
  v_exp_f32 v130, v130
  v_exp_f32 v131, v131
  v_exp_f32 v132, v132
  v_exp_f32 v133, v133
  v_exp_f32 v134, v134
  v_exp_f32 v135, v135
  s_nop 0
  v_pk_add_f32 v[144:145], v[128:129], 2.0 op_sel_hi:[1,0]
  v_pk_add_f32 v[146:147], v[130:131], 2.0 op_sel_hi:[1,0]
  v_pk_add_f32 v[148:149], v[132:133], 2.0 op_sel_hi:[1,0]
  v_pk_add_f32 v[150:151], v[134:135], 2.0 op_sel_hi:[1,0]
  v_pk_fma_f32 v[144:145], v[128:129], v[144:145], 2.0 op_sel_hi:[1,1,0]
  v_pk_fma_f32 v[146:147], v[130:131], v[146:147], 2.0 op_sel_hi:[1,1,0]
  v_pk_fma_f32 v[148:149], v[132:133], v[148:149], 2.0 op_sel_hi:[1,1,0]
  v_pk_fma_f32 v[150:151], v[134:135], v[150:151], 2.0 op_sel_hi:[1,1,0]
  s_waitcnt lgkmcnt(0)
  ds_read_b128 v[104:107], v7 offset:128
  ds_read_b128 v[108:111], v7 offset:576
  v_rcp_f32 v144, v144
  v_pk_fma_f32 v[120:121], v[112:113], v[98:99], v[116:117] op_sel_hi:[1,0,1]
  v_rcp_f32 v145, v145
  v_pk_fma_f32 v[122:123], v[114:115], v[98:99], v[118:119] op_sel_hi:[1,0,1]
  v_rcp_f32 v146, v146
  v_pk_fma_f32 v[124:125], v[112:113], v[102:103], v[116:117] op_sel_hi:[1,0,1]
  v_rcp_f32 v147, v147
  v_pk_fma_f32 v[126:127], v[114:115], v[102:103], v[118:119] op_sel_hi:[1,0,1]
  v_rcp_f32 v148, v148
  v_pk_fma_f32 v[32:33], v[32:33], v[96:97], v[120:121] op_sel_hi:[1,0,1]
  v_rcp_f32 v149, v149
  v_pk_fma_f32 v[34:35], v[34:35], v[96:97], v[122:123] op_sel_hi:[1,0,1]
  v_rcp_f32 v150, v150
  v_pk_fma_f32 v[36:37], v[36:37], v[100:101], v[124:125] op_sel_hi:[1,0,1]
  v_rcp_f32 v151, v151
  v_pk_fma_f32 v[38:39], v[38:39], v[100:101], v[126:127] op_sel_hi:[1,0,1]
  v_pk_mul_f32 v[136:137], v[32:33], s[70:71] op_sel_hi:[1,0]
  v_pk_mul_f32 v[138:139], v[34:35], s[70:71] op_sel_hi:[1,0]
  v_pk_mul_f32 v[140:141], v[36:37], s[70:71] op_sel_hi:[1,0]
  v_pk_mul_f32 v[142:143], v[38:39], s[70:71] op_sel_hi:[1,0]
  v_exp_f32 v136, v136
  v_pk_fma_f32 v[144:145], v[144:145], -2.0, 1.0 op_sel_hi:[1,0,0]
  v_exp_f32 v137, v137
  v_pk_fma_f32 v[146:147], v[146:147], -2.0, 1.0 op_sel_hi:[1,0,0]
  v_exp_f32 v138, v138
  v_pk_fma_f32 v[148:149], v[148:149], -2.0, 1.0 op_sel_hi:[1,0,0]
  v_exp_f32 v139, v139
  v_pk_fma_f32 v[150:151], v[150:151], -2.0, 1.0 op_sel_hi:[1,0,0]
  v_exp_f32 v140, v140
  v_pk_mul_f32 v[144:145], v[144:145], v[24:25]
  v_exp_f32 v141, v141
  v_pk_mul_f32 v[146:147], v[146:147], v[26:27]
  v_exp_f32 v142, v142
  v_pk_mul_f32 v[148:149], v[148:149], v[28:29]
  v_exp_f32 v143, v143
  v_pk_mul_f32 v[150:151], v[150:151], v[30:31]
  v_cvt_pk_bf16_f32 v160, v144, v145
  v_cvt_pk_bf16_f32 v161, v146, v147
  v_cvt_pk_bf16_f32 v162, v148, v149
  v_cvt_pk_bf16_f32 v163, v150, v151
  buffer_store_dwordx4 v[160:163], v5, s[8:11], s64 offen sc1
  s_add_u32 s64, s64, 1024
  s_nop 0
  v_pk_add_f32 v[152:153], v[136:137], 2.0 op_sel_hi:[1,0]
  v_pk_add_f32 v[154:155], v[138:139], 2.0 op_sel_hi:[1,0]
  v_pk_add_f32 v[156:157], v[140:141], 2.0 op_sel_hi:[1,0]
  v_pk_add_f32 v[158:159], v[142:143], 2.0 op_sel_hi:[1,0]
  v_pk_fma_f32 v[152:153], v[136:137], v[152:153], 2.0 op_sel_hi:[1,1,0]
  v_pk_fma_f32 v[154:155], v[138:139], v[154:155], 2.0 op_sel_hi:[1,1,0]
  v_pk_fma_f32 v[156:157], v[140:141], v[156:157], 2.0 op_sel_hi:[1,1,0]
  v_pk_fma_f32 v[158:159], v[142:143], v[158:159], 2.0 op_sel_hi:[1,1,0]
  s_waitcnt lgkmcnt(0)
  ds_read_b128 v[112:115], v7 offset:192
  ds_read_b128 v[116:119], v7 offset:640
  v_rcp_f32 v152, v152
  v_pk_fma_f32 v[120:121], v[104:105], v[98:99], v[108:109] op_sel_hi:[1,0,1]
  v_rcp_f32 v153, v153
  v_pk_fma_f32 v[122:123], v[106:107], v[98:99], v[110:111] op_sel_hi:[1,0,1]
  v_rcp_f32 v154, v154
  v_pk_fma_f32 v[124:125], v[104:105], v[102:103], v[108:109] op_sel_hi:[1,0,1]
  v_rcp_f32 v155, v155
  v_pk_fma_f32 v[126:127], v[106:107], v[102:103], v[110:111] op_sel_hi:[1,0,1]
  v_rcp_f32 v156, v156
  v_pk_fma_f32 v[40:41], v[40:41], v[96:97], v[120:121] op_sel_hi:[1,0,1]
  v_rcp_f32 v157, v157
  v_pk_fma_f32 v[42:43], v[42:43], v[96:97], v[122:123] op_sel_hi:[1,0,1]
  v_rcp_f32 v158, v158
  v_pk_fma_f32 v[44:45], v[44:45], v[100:101], v[124:125] op_sel_hi:[1,0,1]
  v_rcp_f32 v159, v159
  v_pk_fma_f32 v[46:47], v[46:47], v[100:101], v[126:127] op_sel_hi:[1,0,1]
  v_pk_mul_f32 v[128:129], v[40:41], s[70:71] op_sel_hi:[1,0]
  v_pk_mul_f32 v[130:131], v[42:43], s[70:71] op_sel_hi:[1,0]
  v_pk_mul_f32 v[132:133], v[44:45], s[70:71] op_sel_hi:[1,0]
  v_pk_mul_f32 v[134:135], v[46:47], s[70:71] op_sel_hi:[1,0]
  v_exp_f32 v128, v128
  v_pk_fma_f32 v[152:153], v[152:153], -2.0, 1.0 op_sel_hi:[1,0,0]
  v_exp_f32 v129, v129
  v_pk_fma_f32 v[154:155], v[154:155], -2.0, 1.0 op_sel_hi:[1,0,0]
  v_exp_f32 v130, v130
  v_pk_fma_f32 v[156:157], v[156:157], -2.0, 1.0 op_sel_hi:[1,0,0]
  v_exp_f32 v131, v131
  v_pk_fma_f32 v[158:159], v[158:159], -2.0, 1.0 op_sel_hi:[1,0,0]
  v_exp_f32 v132, v132
  v_pk_mul_f32 v[152:153], v[152:153], v[32:33]
  v_exp_f32 v133, v133
  v_pk_mul_f32 v[154:155], v[154:155], v[34:35]
  v_exp_f32 v134, v134
  v_pk_mul_f32 v[156:157], v[156:157], v[36:37]
  v_exp_f32 v135, v135
  v_pk_mul_f32 v[158:159], v[158:159], v[38:39]
  v_cvt_pk_bf16_f32 v164, v152, v153
  v_cvt_pk_bf16_f32 v165, v154, v155
  v_cvt_pk_bf16_f32 v166, v156, v157
  v_cvt_pk_bf16_f32 v167, v158, v159
  buffer_store_dwordx4 v[164:167], v5, s[8:11], s64 offen sc1
  s_add_u32 s64, s64, 1024
  s_nop 0
  v_pk_add_f32 v[144:145], v[128:129], 2.0 op_sel_hi:[1,0]
  v_pk_add_f32 v[146:147], v[130:131], 2.0 op_sel_hi:[1,0]
  v_pk_add_f32 v[148:149], v[132:133], 2.0 op_sel_hi:[1,0]
  v_pk_add_f32 v[150:151], v[134:135], 2.0 op_sel_hi:[1,0]
  v_pk_fma_f32 v[144:145], v[128:129], v[144:145], 2.0 op_sel_hi:[1,1,0]
  v_pk_fma_f32 v[146:147], v[130:131], v[146:147], 2.0 op_sel_hi:[1,1,0]
  v_pk_fma_f32 v[148:149], v[132:133], v[148:149], 2.0 op_sel_hi:[1,1,0]
  v_pk_fma_f32 v[150:151], v[134:135], v[150:151], 2.0 op_sel_hi:[1,1,0]
  s_waitcnt lgkmcnt(0)
  ds_read_b128 v[104:107], v7 offset:256
  ds_read_b128 v[108:111], v7 offset:704
  v_rcp_f32 v144, v144
  v_pk_fma_f32 v[120:121], v[112:113], v[98:99], v[116:117] op_sel_hi:[1,0,1]
  v_rcp_f32 v145, v145
  v_pk_fma_f32 v[122:123], v[114:115], v[98:99], v[118:119] op_sel_hi:[1,0,1]
  v_rcp_f32 v146, v146
  v_pk_fma_f32 v[124:125], v[112:113], v[102:103], v[116:117] op_sel_hi:[1,0,1]
  v_rcp_f32 v147, v147
  v_pk_fma_f32 v[126:127], v[114:115], v[102:103], v[118:119] op_sel_hi:[1,0,1]
  v_rcp_f32 v148, v148
  v_pk_fma_f32 v[48:49], v[48:49], v[96:97], v[120:121] op_sel_hi:[1,0,1]
  v_rcp_f32 v149, v149
  v_pk_fma_f32 v[50:51], v[50:51], v[96:97], v[122:123] op_sel_hi:[1,0,1]
  v_rcp_f32 v150, v150
  v_pk_fma_f32 v[52:53], v[52:53], v[100:101], v[124:125] op_sel_hi:[1,0,1]
  v_rcp_f32 v151, v151
  v_pk_fma_f32 v[54:55], v[54:55], v[100:101], v[126:127] op_sel_hi:[1,0,1]
  v_pk_mul_f32 v[136:137], v[48:49], s[70:71] op_sel_hi:[1,0]
  v_pk_mul_f32 v[138:139], v[50:51], s[70:71] op_sel_hi:[1,0]
  v_pk_mul_f32 v[140:141], v[52:53], s[70:71] op_sel_hi:[1,0]
  v_pk_mul_f32 v[142:143], v[54:55], s[70:71] op_sel_hi:[1,0]
  v_exp_f32 v136, v136
  v_pk_fma_f32 v[144:145], v[144:145], -2.0, 1.0 op_sel_hi:[1,0,0]
  v_exp_f32 v137, v137
  v_pk_fma_f32 v[146:147], v[146:147], -2.0, 1.0 op_sel_hi:[1,0,0]
  v_exp_f32 v138, v138
  v_pk_fma_f32 v[148:149], v[148:149], -2.0, 1.0 op_sel_hi:[1,0,0]
  v_exp_f32 v139, v139
  v_pk_fma_f32 v[150:151], v[150:151], -2.0, 1.0 op_sel_hi:[1,0,0]
  v_exp_f32 v140, v140
  v_pk_mul_f32 v[144:145], v[144:145], v[40:41]
  v_exp_f32 v141, v141
  v_pk_mul_f32 v[146:147], v[146:147], v[42:43]
  v_exp_f32 v142, v142
  v_pk_mul_f32 v[148:149], v[148:149], v[44:45]
  v_exp_f32 v143, v143
  v_pk_mul_f32 v[150:151], v[150:151], v[46:47]
  v_cvt_pk_bf16_f32 v160, v144, v145
  v_cvt_pk_bf16_f32 v161, v146, v147
  v_cvt_pk_bf16_f32 v162, v148, v149
  v_cvt_pk_bf16_f32 v163, v150, v151
  buffer_store_dwordx4 v[160:163], v5, s[8:11], s64 offen sc1
  s_add_u32 s64, s64, 1024
  s_nop 0
  v_pk_add_f32 v[152:153], v[136:137], 2.0 op_sel_hi:[1,0]
  v_pk_add_f32 v[154:155], v[138:139], 2.0 op_sel_hi:[1,0]
  v_pk_add_f32 v[156:157], v[140:141], 2.0 op_sel_hi:[1,0]
  v_pk_add_f32 v[158:159], v[142:143], 2.0 op_sel_hi:[1,0]
  v_pk_fma_f32 v[152:153], v[136:137], v[152:153], 2.0 op_sel_hi:[1,1,0]
  v_pk_fma_f32 v[154:155], v[138:139], v[154:155], 2.0 op_sel_hi:[1,1,0]
  v_pk_fma_f32 v[156:157], v[140:141], v[156:157], 2.0 op_sel_hi:[1,1,0]
  v_pk_fma_f32 v[158:159], v[142:143], v[158:159], 2.0 op_sel_hi:[1,1,0]
  s_waitcnt lgkmcnt(0)
  ds_read_b128 v[112:115], v7 offset:320
  ds_read_b128 v[116:119], v7 offset:768
  v_rcp_f32 v152, v152
  v_pk_fma_f32 v[120:121], v[104:105], v[98:99], v[108:109] op_sel_hi:[1,0,1]
  v_rcp_f32 v153, v153
  v_pk_fma_f32 v[122:123], v[106:107], v[98:99], v[110:111] op_sel_hi:[1,0,1]
  v_rcp_f32 v154, v154
  v_pk_fma_f32 v[124:125], v[104:105], v[102:103], v[108:109] op_sel_hi:[1,0,1]
  v_rcp_f32 v155, v155
  v_pk_fma_f32 v[126:127], v[106:107], v[102:103], v[110:111] op_sel_hi:[1,0,1]
  v_rcp_f32 v156, v156
  v_pk_fma_f32 v[56:57], v[56:57], v[96:97], v[120:121] op_sel_hi:[1,0,1]
  v_rcp_f32 v157, v157
  v_pk_fma_f32 v[58:59], v[58:59], v[96:97], v[122:123] op_sel_hi:[1,0,1]
  v_rcp_f32 v158, v158
  v_pk_fma_f32 v[60:61], v[60:61], v[100:101], v[124:125] op_sel_hi:[1,0,1]
  v_rcp_f32 v159, v159
  v_pk_fma_f32 v[62:63], v[62:63], v[100:101], v[126:127] op_sel_hi:[1,0,1]
  v_pk_mul_f32 v[128:129], v[56:57], s[70:71] op_sel_hi:[1,0]
  v_pk_mul_f32 v[130:131], v[58:59], s[70:71] op_sel_hi:[1,0]
  v_pk_mul_f32 v[132:133], v[60:61], s[70:71] op_sel_hi:[1,0]
  v_pk_mul_f32 v[134:135], v[62:63], s[70:71] op_sel_hi:[1,0]
  v_exp_f32 v128, v128
  v_pk_fma_f32 v[152:153], v[152:153], -2.0, 1.0 op_sel_hi:[1,0,0]
  v_exp_f32 v129, v129
  v_pk_fma_f32 v[154:155], v[154:155], -2.0, 1.0 op_sel_hi:[1,0,0]
  v_exp_f32 v130, v130
  v_pk_fma_f32 v[156:157], v[156:157], -2.0, 1.0 op_sel_hi:[1,0,0]
  v_exp_f32 v131, v131
  v_pk_fma_f32 v[158:159], v[158:159], -2.0, 1.0 op_sel_hi:[1,0,0]
  v_exp_f32 v132, v132
  v_pk_mul_f32 v[152:153], v[152:153], v[48:49]
  v_exp_f32 v133, v133
  v_pk_mul_f32 v[154:155], v[154:155], v[50:51]
  v_exp_f32 v134, v134
  v_pk_mul_f32 v[156:157], v[156:157], v[52:53]
  v_exp_f32 v135, v135
  v_pk_mul_f32 v[158:159], v[158:159], v[54:55]
  v_cvt_pk_bf16_f32 v164, v152, v153
  v_cvt_pk_bf16_f32 v165, v154, v155
  v_cvt_pk_bf16_f32 v166, v156, v157
  v_cvt_pk_bf16_f32 v167, v158, v159
  buffer_store_dwordx4 v[164:167], v5, s[8:11], s64 offen sc1
  s_add_u32 s64, s64, 1024
  s_nop 0
  v_pk_add_f32 v[144:145], v[128:129], 2.0 op_sel_hi:[1,0]
  v_pk_add_f32 v[146:147], v[130:131], 2.0 op_sel_hi:[1,0]
  v_pk_add_f32 v[148:149], v[132:133], 2.0 op_sel_hi:[1,0]
  v_pk_add_f32 v[150:151], v[134:135], 2.0 op_sel_hi:[1,0]
  v_pk_fma_f32 v[144:145], v[128:129], v[144:145], 2.0 op_sel_hi:[1,1,0]
  v_pk_fma_f32 v[146:147], v[130:131], v[146:147], 2.0 op_sel_hi:[1,1,0]
  v_pk_fma_f32 v[148:149], v[132:133], v[148:149], 2.0 op_sel_hi:[1,1,0]
  v_pk_fma_f32 v[150:151], v[134:135], v[150:151], 2.0 op_sel_hi:[1,1,0]
  s_waitcnt lgkmcnt(0)
  ds_read_b128 v[104:107], v7 offset:384
  ds_read_b128 v[108:111], v7 offset:832
  v_rcp_f32 v144, v144
  v_pk_fma_f32 v[120:121], v[112:113], v[98:99], v[116:117] op_sel_hi:[1,0,1]
  v_rcp_f32 v145, v145
  v_pk_fma_f32 v[122:123], v[114:115], v[98:99], v[118:119] op_sel_hi:[1,0,1]
  v_rcp_f32 v146, v146
  v_pk_fma_f32 v[124:125], v[112:113], v[102:103], v[116:117] op_sel_hi:[1,0,1]
  v_rcp_f32 v147, v147
  v_pk_fma_f32 v[126:127], v[114:115], v[102:103], v[118:119] op_sel_hi:[1,0,1]
  v_rcp_f32 v148, v148
  v_pk_fma_f32 v[64:65], v[64:65], v[96:97], v[120:121] op_sel_hi:[1,0,1]
  v_rcp_f32 v149, v149
  v_pk_fma_f32 v[66:67], v[66:67], v[96:97], v[122:123] op_sel_hi:[1,0,1]
  v_rcp_f32 v150, v150
  v_pk_fma_f32 v[68:69], v[68:69], v[100:101], v[124:125] op_sel_hi:[1,0,1]
  v_rcp_f32 v151, v151
  v_pk_fma_f32 v[70:71], v[70:71], v[100:101], v[126:127] op_sel_hi:[1,0,1]
  v_pk_mul_f32 v[136:137], v[64:65], s[70:71] op_sel_hi:[1,0]
  v_pk_mul_f32 v[138:139], v[66:67], s[70:71] op_sel_hi:[1,0]
  v_pk_mul_f32 v[140:141], v[68:69], s[70:71] op_sel_hi:[1,0]
  v_pk_mul_f32 v[142:143], v[70:71], s[70:71] op_sel_hi:[1,0]
  v_exp_f32 v136, v136
  v_pk_fma_f32 v[144:145], v[144:145], -2.0, 1.0 op_sel_hi:[1,0,0]
  v_exp_f32 v137, v137
  v_pk_fma_f32 v[146:147], v[146:147], -2.0, 1.0 op_sel_hi:[1,0,0]
  v_exp_f32 v138, v138
  v_pk_fma_f32 v[148:149], v[148:149], -2.0, 1.0 op_sel_hi:[1,0,0]
  v_exp_f32 v139, v139
  v_pk_fma_f32 v[150:151], v[150:151], -2.0, 1.0 op_sel_hi:[1,0,0]
  v_exp_f32 v140, v140
  v_pk_mul_f32 v[144:145], v[144:145], v[56:57]
  v_exp_f32 v141, v141
  v_pk_mul_f32 v[146:147], v[146:147], v[58:59]
  v_exp_f32 v142, v142
  v_pk_mul_f32 v[148:149], v[148:149], v[60:61]
  v_exp_f32 v143, v143
  v_pk_mul_f32 v[150:151], v[150:151], v[62:63]
  v_cvt_pk_bf16_f32 v160, v144, v145
  v_cvt_pk_bf16_f32 v161, v146, v147
  v_cvt_pk_bf16_f32 v162, v148, v149
  v_cvt_pk_bf16_f32 v163, v150, v151
  buffer_store_dwordx4 v[160:163], v5, s[8:11], s64 offen sc1
  s_add_u32 s64, s64, 1024
  s_nop 0
  v_pk_add_f32 v[152:153], v[136:137], 2.0 op_sel_hi:[1,0]
  v_pk_add_f32 v[154:155], v[138:139], 2.0 op_sel_hi:[1,0]
  v_pk_add_f32 v[156:157], v[140:141], 2.0 op_sel_hi:[1,0]
  v_pk_add_f32 v[158:159], v[142:143], 2.0 op_sel_hi:[1,0]
  v_pk_fma_f32 v[152:153], v[136:137], v[152:153], 2.0 op_sel_hi:[1,1,0]
  v_pk_fma_f32 v[154:155], v[138:139], v[154:155], 2.0 op_sel_hi:[1,1,0]
  v_pk_fma_f32 v[156:157], v[140:141], v[156:157], 2.0 op_sel_hi:[1,1,0]
  v_pk_fma_f32 v[158:159], v[142:143], v[158:159], 2.0 op_sel_hi:[1,1,0]
  s_waitcnt lgkmcnt(0)
  v_rcp_f32 v152, v152
  v_pk_fma_f32 v[120:121], v[104:105], v[98:99], v[108:109] op_sel_hi:[1,0,1]
  v_rcp_f32 v153, v153
  v_pk_fma_f32 v[122:123], v[106:107], v[98:99], v[110:111] op_sel_hi:[1,0,1]
  v_rcp_f32 v154, v154
  v_pk_fma_f32 v[124:125], v[104:105], v[102:103], v[108:109] op_sel_hi:[1,0,1]
  v_rcp_f32 v155, v155
  v_pk_fma_f32 v[126:127], v[106:107], v[102:103], v[110:111] op_sel_hi:[1,0,1]
  v_rcp_f32 v156, v156
  v_pk_fma_f32 v[72:73], v[72:73], v[96:97], v[120:121] op_sel_hi:[1,0,1]
  v_rcp_f32 v157, v157
  v_pk_fma_f32 v[74:75], v[74:75], v[96:97], v[122:123] op_sel_hi:[1,0,1]
  v_rcp_f32 v158, v158
  v_pk_fma_f32 v[76:77], v[76:77], v[100:101], v[124:125] op_sel_hi:[1,0,1]
  v_rcp_f32 v159, v159
  v_pk_fma_f32 v[78:79], v[78:79], v[100:101], v[126:127] op_sel_hi:[1,0,1]
  v_pk_mul_f32 v[128:129], v[72:73], s[70:71] op_sel_hi:[1,0]
  v_pk_mul_f32 v[130:131], v[74:75], s[70:71] op_sel_hi:[1,0]
  v_pk_mul_f32 v[132:133], v[76:77], s[70:71] op_sel_hi:[1,0]
  v_pk_mul_f32 v[134:135], v[78:79], s[70:71] op_sel_hi:[1,0]
  v_exp_f32 v128, v128
  v_pk_fma_f32 v[152:153], v[152:153], -2.0, 1.0 op_sel_hi:[1,0,0]
  v_exp_f32 v129, v129
  v_pk_fma_f32 v[154:155], v[154:155], -2.0, 1.0 op_sel_hi:[1,0,0]
  v_exp_f32 v130, v130
  v_pk_fma_f32 v[156:157], v[156:157], -2.0, 1.0 op_sel_hi:[1,0,0]
  v_exp_f32 v131, v131
  v_pk_fma_f32 v[158:159], v[158:159], -2.0, 1.0 op_sel_hi:[1,0,0]
  v_exp_f32 v132, v132
  v_pk_mul_f32 v[152:153], v[152:153], v[64:65]
  v_exp_f32 v133, v133
  v_pk_mul_f32 v[154:155], v[154:155], v[66:67]
  v_exp_f32 v134, v134
  v_pk_mul_f32 v[156:157], v[156:157], v[68:69]
  v_exp_f32 v135, v135
  v_pk_mul_f32 v[158:159], v[158:159], v[70:71]
  v_cvt_pk_bf16_f32 v164, v152, v153
  v_cvt_pk_bf16_f32 v165, v154, v155
  v_cvt_pk_bf16_f32 v166, v156, v157
  v_cvt_pk_bf16_f32 v167, v158, v159
  buffer_store_dwordx4 v[164:167], v5, s[8:11], s64 offen sc1
  s_add_u32 s64, s64, 1024
  s_nop 0
  v_pk_add_f32 v[144:145], v[128:129], 2.0 op_sel_hi:[1,0]
  v_pk_add_f32 v[146:147], v[130:131], 2.0 op_sel_hi:[1,0]
  v_pk_add_f32 v[148:149], v[132:133], 2.0 op_sel_hi:[1,0]
  v_pk_add_f32 v[150:151], v[134:135], 2.0 op_sel_hi:[1,0]
  v_pk_fma_f32 v[144:145], v[128:129], v[144:145], 2.0 op_sel_hi:[1,1,0]
  v_pk_fma_f32 v[146:147], v[130:131], v[146:147], 2.0 op_sel_hi:[1,1,0]
  v_pk_fma_f32 v[148:149], v[132:133], v[148:149], 2.0 op_sel_hi:[1,1,0]
  v_pk_fma_f32 v[150:151], v[134:135], v[150:151], 2.0 op_sel_hi:[1,1,0]
  v_rcp_f32 v144, v144
  v_rcp_f32 v145, v145
  v_rcp_f32 v146, v146
  v_rcp_f32 v147, v147
  v_rcp_f32 v148, v148
  v_rcp_f32 v149, v149
  v_rcp_f32 v150, v150
  v_rcp_f32 v151, v151
  s_nop 0
  v_pk_fma_f32 v[144:145], v[144:145], -2.0, 1.0 op_sel_hi:[1,0,0]
  v_pk_fma_f32 v[146:147], v[146:147], -2.0, 1.0 op_sel_hi:[1,0,0]
  v_pk_fma_f32 v[148:149], v[148:149], -2.0, 1.0 op_sel_hi:[1,0,0]
  v_pk_fma_f32 v[150:151], v[150:151], -2.0, 1.0 op_sel_hi:[1,0,0]
  v_pk_mul_f32 v[144:145], v[144:145], v[72:73]
  v_pk_mul_f32 v[146:147], v[146:147], v[74:75]
  v_pk_mul_f32 v[148:149], v[148:149], v[76:77]
  v_pk_mul_f32 v[150:151], v[150:151], v[78:79]
  v_cvt_pk_bf16_f32 v160, v144, v145
  v_cvt_pk_bf16_f32 v161, v146, v147
  v_cvt_pk_bf16_f32 v162, v148, v149
  v_cvt_pk_bf16_f32 v163, v150, v151
  s_and_b32 s65, s2, 1
  s_lshl_b32 s65, s65, 3
  s_lshr_b32 s66, s2, 5
  s_add_u32 s65, s65, s66
  s_lshl_b32 s65, s65, 2
  s_add_u32 s66, s4, 49
  s_lshl_b32 s66, s66, 7
  s_add_u32 s66, s66, s65
  s_add_u32 s66, s66, 14598144
  s_waitcnt vmcnt(2)
  s_barrier
  s_cmp_lg_u32 s3, 0
  s_cbranch_scc1 sequential_preLN__ssm_conv_s4__dense_activation_mish__prompt_kernel_s3a_22
  v_mov_b32 v4, 1
  v_mov_b32 v12, 0
  s_mov_b64 exec, 1
  buffer_store_dword v4, v12, s[8:11], s66 offen sc1
  s_mov_b64 exec, -1
sequential_preLN__ssm_conv_s4__dense_activation_mish__prompt_kernel_s3a_22:
  buffer_store_dwordx4 v[160:163], v5, s[8:11], s64 offen sc1
  s_and_b32 s65, s2, 1
  s_lshl_b32 s65, s65, 3
  s_lshr_b32 s66, s2, 5
  s_add_u32 s65, s65, s66
  s_lshl_b32 s65, s65, 2
  s_add_u32 s64, s4, 33
  s_lshl_b32 s64, s64, 7
  s_add_u32 s64, s64, s65
  s_add_u32 s64, s64, 14598144
  s_waitcnt vmcnt(0)
  s_barrier
  s_cmp_lg_u32 s3, 0
  s_cbranch_scc1 sequential_preLN__ssm_conv_s4__dense_activation_mish__prompt_kernel_s3f_23
  v_mov_b32 v4, 1
  v_mov_b32 v7, 0
  s_mov_b64 exec, 1
  buffer_store_dword v4, v7, s[8:11], s64 offen sc1
  s_mov_b64 exec, -1
sequential_preLN__ssm_conv_s4__dense_activation_mish__prompt_kernel_s3f_23:
  s_mul_i32 s68, s3, 14
  s_mul_i32 s70, s6, 216
  s_lshl_b32 s71, s68, 1
  s_add_u32 s70, s70, s71
  s_lshl_b32 s70, s70, 10
  s_add_u32 s70, s70, 4898816
  s_lshl_b32 s64, s6, 1
  s_lshr_b32 s65, s3, 1
  s_add_u32 s64, s64, s65
  s_mul_i32 s79, s64, 40960
  s_and_b32 s67, s3, 1
  s_lshl_b32 s67, s67, 3
  s_add_u32 s79, s79, s67
  s_add_u32 s79, s79, 2277376
  s_mul_i32 s67, s7, 20
  v_lshlrev_b32 v8, 1, v3
  v_add_u32 v8, 0, v8
  v_add_u32 v8, s67, v8
  v_lshrrev_b32 v9, 3, v8
  v_lshlrev_b32 v9, 11, v9
  v_bfe_u32 v10, v8, 2, 1
  v_lshl_add_u32 v9, v10, 10, v9
  v_and_b32 v10, 3, v8
  v_lshl_add_u32 v9, v10, 8, v9
  v_lshl_add_u32 v18, v2, 4, v9
  v_lshlrev_b32 v8, 1, v3
  v_add_u32 v8, 1, v8
  v_add_u32 v8, s67, v8
  v_lshrrev_b32 v9, 3, v8
  v_lshlrev_b32 v9, 11, v9
  v_bfe_u32 v10, v8, 2, 1
  v_lshl_add_u32 v9, v10, 10, v9
  v_and_b32 v10, 3, v8
  v_lshl_add_u32 v9, v10, 8, v9
  v_lshl_add_u32 v19, v2, 4, v9
  v_lshlrev_b32 v8, 1, v3
  v_add_u32 v8, 8, v8
  v_add_u32 v8, s67, v8
  v_lshrrev_b32 v9, 3, v8
  v_lshlrev_b32 v9, 11, v9
  v_bfe_u32 v10, v8, 2, 1
  v_lshl_add_u32 v9, v10, 10, v9
  v_and_b32 v10, 3, v8
  v_lshl_add_u32 v9, v10, 8, v9
  v_lshl_add_u32 v20, v2, 4, v9
  v_lshlrev_b32 v8, 1, v3
  v_add_u32 v8, 9, v8
  v_add_u32 v8, s67, v8
  v_lshrrev_b32 v9, 3, v8
  v_lshlrev_b32 v9, 11, v9
  v_bfe_u32 v10, v8, 2, 1
  v_lshl_add_u32 v9, v10, 10, v9
  v_and_b32 v10, 3, v8
  v_lshl_add_u32 v9, v10, 8, v9
  v_lshl_add_u32 v21, v2, 4, v9
  v_add_u32 v8, 16, v3
  v_add_u32 v8, s67, v8
  v_lshrrev_b32 v9, 3, v8
  v_lshlrev_b32 v9, 11, v9
  v_bfe_u32 v10, v8, 2, 1
  v_lshl_add_u32 v9, v10, 10, v9
  v_and_b32 v10, 3, v8
  v_lshl_add_u32 v9, v10, 8, v9
  v_lshl_add_u32 v22, v2, 4, v9
  s_lshr_b32 s64, s6, 1
  s_add_u32 s64, s64, 49
  s_lshl_b32 s64, s64, 7
  s_add_u32 s64, s64, 14598144
  s_sub_u32 s69, s64, 2048
  s_cmp_lg_u32 s3, 0
  s_cbranch_scc1 sequential_preLN__ssm_conv_s4__dense_activation_mish__prompt_kernel_pfs_26
  v_lshlrev_b32 v7, 2, v1
  s_mov_b64 exec, 65535
  s_mov_b32 s66, 0
sequential_preLN__ssm_conv_s4__dense_activation_mish__prompt_kernel_pf_24:
  buffer_load_dword v4, v7, s[8:11], s64 offen sc1
  s_add_u32 s66, s66, 1
  s_waitcnt vmcnt(0)
  v_cmp_eq_u32 vcc, 0, v4
  s_cmp_gt_u32 s66, 400000
  s_cbranch_scc1 sequential_preLN__ssm_conv_s4__dense_activation_mish__prompt_kernel_pfd_25
  s_cbranch_vccz sequential_preLN__ssm_conv_s4__dense_activation_mish__prompt_kernel_pfd_25
  s_sleep 1
  s_branch sequential_preLN__ssm_conv_s4__dense_activation_mish__prompt_kernel_pf_24
sequential_preLN__ssm_conv_s4__dense_activation_mish__prompt_kernel_pfd_25:
  s_mov_b64 exec, -1
sequential_preLN__ssm_conv_s4__dense_activation_mish__prompt_kernel_pfs_26:
  s_barrier
  s_add_u32 s71, s70, 0
  buffer_load_dwordx4 v[104:107], v5, s[8:11], s71 offen sc1
  buffer_load_dwordx4 v[108:111], v5, s[8:11], s71 offen offset:1024 sc1
  s_add_u32 s72, s70, 110592
  buffer_load_dwordx4 v[112:115], v5, s[8:11], s72 offen sc1
  buffer_load_dwordx4 v[116:119], v5, s[8:11], s72 offen offset:1024 sc1
  s_add_u32 s71, s70, 2048
  buffer_load_dwordx4 v[120:123], v5, s[8:11], s71 offen sc1
  buffer_load_dwordx4 v[124:127], v5, s[8:11], s71 offen offset:1024 sc1
  s_add_u32 s72, s70, 112640
  buffer_load_dwordx4 v[128:131], v5, s[8:11], s72 offen sc1
  buffer_load_dwordx4 v[132:135], v5, s[8:11], s72 offen offset:1024 sc1
  s_add_u32 s71, s70, 8192
  buffer_load_dwordx4 v[136:139], v5, s[8:11], s71 offen sc1
  buffer_load_dwordx4 v[140:143], v5, s[8:11], s71 offen offset:1024 sc1
  s_add_u32 s72, s70, 118784
  buffer_load_dwordx4 v[144:147], v5, s[8:11], s72 offen sc1
  buffer_load_dwordx4 v[148:151], v5, s[8:11], s72 offen offset:1024 sc1
  s_add_u32 s71, s70, 14336
  buffer_load_dwordx4 v[152:155], v5, s[8:11], s71 offen sc1
  buffer_load_dwordx4 v[156:159], v5, s[8:11], s71 offen offset:1024 sc1
  s_add_u32 s72, s70, 124928
  buffer_load_dwordx4 v[160:163], v5, s[8:11], s72 offen sc1
  buffer_load_dwordx4 v[164:167], v5, s[8:11], s72 offen offset:1024 sc1
  buffer_load_dwordx2 v[8:9], v18, s[8:11], s79 offen sc1
  buffer_load_dwordx2 v[10:11], v19, s[8:11], s79 offen sc1
  buffer_load_dwordx2 v[12:13], v20, s[8:11], s79 offen sc1
  buffer_load_dwordx2 v[14:15], v21, s[8:11], s79 offen sc1
  buffer_load_dwordx2 v[16:17], v22, s[8:11], s79 offen sc1
  s_waitcnt vmcnt(17)
  v_swap_b32 v106, v108
  v_swap_b32 v107, v109
  v_swap_b32 v114, v116
  v_swap_b32 v115, v117
  v_lshlrev_b32 v23, 2, v1
  v_and_b32 v23, 63, v23
  v_mfma_f32_16x16x32_bf16 v[24:27], a[56:59], v[104:107], 0
  v_mfma_f32_16x16x32_bf16 v[28:31], a[56:59], v[108:111], 0
  v_mfma_f32_16x16x32_bf16 v[32:35], a[56:59], v[112:115], 0
  v_mfma_f32_16x16x32_bf16 v[36:39], a[56:59], v[116:119], 0
  v_mfma_f32_16x16x32_bf16 v[40:43], a[60:63], v[104:107], 0
  v_mfma_f32_16x16x32_bf16 v[44:47], a[60:63], v[108:111], 0
  v_mfma_f32_16x16x32_bf16 v[48:51], a[60:63], v[112:115], 0
  v_mfma_f32_16x16x32_bf16 v[52:55], a[60:63], v[116:119], 0
  v_mfma_f32_16x16x32_bf16 v[56:59], a[64:67], v[104:107], 0
  v_mfma_f32_16x16x32_bf16 v[60:63], a[64:67], v[108:111], 0
  buffer_load_dword v4, v23, s[8:11], s69 offen sc1
  v_mfma_f32_16x16x32_bf16 v[64:67], a[64:67], v[112:115], 0
  v_mfma_f32_16x16x32_bf16 v[68:71], a[64:67], v[116:119], 0
  v_mfma_f32_16x16x32_bf16 v[72:75], a[68:71], v[104:107], 0
  v_mfma_f32_16x16x32_bf16 v[76:79], a[68:71], v[108:111], 0
  s_waitcnt vmcnt(14)
  v_swap_b32 v122, v124
  v_swap_b32 v123, v125
  v_swap_b32 v130, v132
  v_swap_b32 v131, v133
  v_mfma_f32_16x16x32_bf16 v[80:83], a[68:71], v[112:115], 0
  v_mfma_f32_16x16x32_bf16 v[84:87], a[68:71], v[116:119], 0
  v_mfma_f32_16x16x32_bf16 v[88:91], a[72:75], v[104:107], 0
  v_mfma_f32_16x16x32_bf16 v[92:95], a[72:75], v[108:111], 0
  v_mfma_f32_16x16x32_bf16 v[96:99], a[72:75], v[112:115], 0
  v_mfma_f32_16x16x32_bf16 v[100:103], a[72:75], v[116:119], 0
  v_mfma_f32_16x16x32_bf16 v[24:27], a[76:79], v[120:123], v[24:27]
  s_add_u32 s71, s70, 16384
  buffer_load_dwordx4 v[104:107], v5, s[8:11], s71 offen sc1
  v_mfma_f32_16x16x32_bf16 v[28:31], a[76:79], v[124:127], v[28:31]
  v_mfma_f32_16x16x32_bf16 v[32:35], a[76:79], v[128:131], v[32:35]
  buffer_load_dwordx4 v[108:111], v5, s[8:11], s71 offen offset:1024 sc1
  v_mfma_f32_16x16x32_bf16 v[36:39], a[76:79], v[132:135], v[36:39]
  v_mfma_f32_16x16x32_bf16 v[40:43], a[80:83], v[120:123], v[40:43]
  s_add_u32 s72, s70, 126976
  buffer_load_dwordx4 v[112:115], v5, s[8:11], s72 offen sc1
  v_mfma_f32_16x16x32_bf16 v[44:47], a[80:83], v[124:127], v[44:47]
  v_mfma_f32_16x16x32_bf16 v[48:51], a[80:83], v[128:131], v[48:51]
  buffer_load_dwordx4 v[116:119], v5, s[8:11], s72 offen offset:1024 sc1
  v_mfma_f32_16x16x32_bf16 v[52:55], a[80:83], v[132:135], v[52:55]
  v_mfma_f32_16x16x32_bf16 v[56:59], a[84:87], v[120:123], v[56:59]
  v_mfma_f32_16x16x32_bf16 v[60:63], a[84:87], v[124:127], v[60:63]
  v_mfma_f32_16x16x32_bf16 v[64:67], a[84:87], v[128:131], v[64:67]
  v_mfma_f32_16x16x32_bf16 v[68:71], a[84:87], v[132:135], v[68:71]
  v_mfma_f32_16x16x32_bf16 v[72:75], a[88:91], v[120:123], v[72:75]
  v_mfma_f32_16x16x32_bf16 v[76:79], a[88:91], v[124:127], v[76:79]
  s_waitcnt vmcnt(14)
  v_swap_b32 v138, v140
  v_swap_b32 v139, v141
  v_swap_b32 v146, v148
  v_swap_b32 v147, v149
  v_mfma_f32_16x16x32_bf16 v[80:83], a[88:91], v[128:131], v[80:83]
  v_mfma_f32_16x16x32_bf16 v[84:87], a[88:91], v[132:135], v[84:87]
  v_mfma_f32_16x16x32_bf16 v[88:91], a[92:95], v[120:123], v[88:91]
  v_mfma_f32_16x16x32_bf16 v[92:95], a[92:95], v[124:127], v[92:95]
  v_mfma_f32_16x16x32_bf16 v[96:99], a[92:95], v[128:131], v[96:99]
  v_mfma_f32_16x16x32_bf16 v[100:103], a[92:95], v[132:135], v[100:103]
  s_waitcnt vmcnt(4)
  v_cmp_eq_u32 vcc, 0, v4
  s_cbranch_vccnz g2_slowB
g2_okB:
  v_mfma_f32_16x16x32_bf16 v[24:27], a[136:139], v[136:139], v[24:27]
  s_add_u32 s71, s70, 4096
  buffer_load_dwordx4 v[120:123], v5, s[8:11], s71 offen sc1
  v_mfma_f32_16x16x32_bf16 v[28:31], a[136:139], v[140:143], v[28:31]
  v_mfma_f32_16x16x32_bf16 v[32:35], a[136:139], v[144:147], v[32:35]
  buffer_load_dwordx4 v[124:127], v5, s[8:11], s71 offen offset:1024 sc1
  v_mfma_f32_16x16x32_bf16 v[36:39], a[136:139], v[148:151], v[36:39]
  v_mfma_f32_16x16x32_bf16 v[40:43], a[140:143], v[136:139], v[40:43]
  s_add_u32 s72, s70, 114688
  buffer_load_dwordx4 v[128:131], v5, s[8:11], s72 offen sc1
  v_mfma_f32_16x16x32_bf16 v[44:47], a[140:143], v[140:143], v[44:47]
  v_mfma_f32_16x16x32_bf16 v[48:51], a[140:143], v[144:147], v[48:51]
  buffer_load_dwordx4 v[132:135], v5, s[8:11], s72 offen offset:1024 sc1
  v_mfma_f32_16x16x32_bf16 v[52:55], a[140:143], v[148:151], v[52:55]
  v_mfma_f32_16x16x32_bf16 v[56:59], a[144:147], v[136:139], v[56:59]
  v_mfma_f32_16x16x32_bf16 v[60:63], a[144:147], v[140:143], v[60:63]
  v_mfma_f32_16x16x32_bf16 v[64:67], a[144:147], v[144:147], v[64:67]
  v_mfma_f32_16x16x32_bf16 v[68:71], a[144:147], v[148:151], v[68:71]
  v_mfma_f32_16x16x32_bf16 v[72:75], a[148:151], v[136:139], v[72:75]
  v_mfma_f32_16x16x32_bf16 v[76:79], a[148:151], v[140:143], v[76:79]
  s_waitcnt vmcnt(14)
  v_swap_b32 v154, v156
  v_swap_b32 v155, v157
  v_swap_b32 v162, v164
  v_swap_b32 v163, v165
  v_mfma_f32_16x16x32_bf16 v[80:83], a[148:151], v[144:147], v[80:83]
  v_mfma_f32_16x16x32_bf16 v[84:87], a[148:151], v[148:151], v[84:87]
  v_mfma_f32_16x16x32_bf16 v[88:91], a[152:155], v[136:139], v[88:91]
  v_mfma_f32_16x16x32_bf16 v[92:95], a[152:155], v[140:143], v[92:95]
  v_mfma_f32_16x16x32_bf16 v[96:99], a[152:155], v[144:147], v[96:99]
  v_mfma_f32_16x16x32_bf16 v[100:103], a[152:155], v[148:151], v[100:103]
  v_mfma_f32_16x16x32_bf16 v[24:27], a[196:199], v[152:155], v[24:27]
  s_add_u32 s71, s70, 6144
  buffer_load_dwordx4 v[136:139], v5, s[8:11], s71 offen sc1
  v_mfma_f32_16x16x32_bf16 v[28:31], a[196:199], v[156:159], v[28:31]
  v_mfma_f32_16x16x32_bf16 v[32:35], a[196:199], v[160:163], v[32:35]
  buffer_load_dwordx4 v[140:143], v5, s[8:11], s71 offen offset:1024 sc1
  v_mfma_f32_16x16x32_bf16 v[36:39], a[196:199], v[164:167], v[36:39]
  v_mfma_f32_16x16x32_bf16 v[40:43], a[200:203], v[152:155], v[40:43]
  s_add_u32 s72, s70, 116736
  buffer_load_dwordx4 v[144:147], v5, s[8:11], s72 offen sc1
  v_mfma_f32_16x16x32_bf16 v[44:47], a[200:203], v[156:159], v[44:47]
  v_mfma_f32_16x16x32_bf16 v[48:51], a[200:203], v[160:163], v[48:51]
  buffer_load_dwordx4 v[148:151], v5, s[8:11], s72 offen offset:1024 sc1
  v_mfma_f32_16x16x32_bf16 v[52:55], a[200:203], v[164:167], v[52:55]
  v_mfma_f32_16x16x32_bf16 v[56:59], a[204:207], v[152:155], v[56:59]
  v_mfma_f32_16x16x32_bf16 v[60:63], a[204:207], v[156:159], v[60:63]
  v_mfma_f32_16x16x32_bf16 v[64:67], a[204:207], v[160:163], v[64:67]
  v_mfma_f32_16x16x32_bf16 v[68:71], a[204:207], v[164:167], v[68:71]
  v_mfma_f32_16x16x32_bf16 v[72:75], a[208:211], v[152:155], v[72:75]
  v_mfma_f32_16x16x32_bf16 v[76:79], a[208:211], v[156:159], v[76:79]
  s_waitcnt vmcnt(8)
  v_swap_b32 v106, v108
  v_swap_b32 v107, v109
  v_swap_b32 v114, v116
  v_swap_b32 v115, v117
  v_mfma_f32_16x16x32_bf16 v[80:83], a[208:211], v[160:163], v[80:83]
  v_mfma_f32_16x16x32_bf16 v[84:87], a[208:211], v[164:167], v[84:87]
  v_mfma_f32_16x16x32_bf16 v[88:91], a[212:215], v[152:155], v[88:91]
  v_mfma_f32_16x16x32_bf16 v[92:95], a[212:215], v[156:159], v[92:95]
  v_mfma_f32_16x16x32_bf16 v[96:99], a[212:215], v[160:163], v[96:99]
  v_mfma_f32_16x16x32_bf16 v[100:103], a[212:215], v[164:167], v[100:103]
  v_mfma_f32_16x16x32_bf16 v[24:27], a[216:219], v[104:107], v[24:27]
  s_add_u32 s71, s70, 10240
  buffer_load_dwordx4 v[152:155], v5, s[8:11], s71 offen sc1
  v_mfma_f32_16x16x32_bf16 v[28:31], a[216:219], v[108:111], v[28:31]
  v_mfma_f32_16x16x32_bf16 v[32:35], a[216:219], v[112:115], v[32:35]
  buffer_load_dwordx4 v[156:159], v5, s[8:11], s71 offen offset:1024 sc1
  v_mfma_f32_16x16x32_bf16 v[36:39], a[216:219], v[116:119], v[36:39]
  v_mfma_f32_16x16x32_bf16 v[40:43], a[220:223], v[104:107], v[40:43]
  s_add_u32 s72, s70, 120832
  buffer_load_dwordx4 v[160:163], v5, s[8:11], s72 offen sc1
  v_mfma_f32_16x16x32_bf16 v[44:47], a[220:223], v[108:111], v[44:47]
  v_mfma_f32_16x16x32_bf16 v[48:51], a[220:223], v[112:115], v[48:51]
  buffer_load_dwordx4 v[164:167], v5, s[8:11], s72 offen offset:1024 sc1
  v_mfma_f32_16x16x32_bf16 v[52:55], a[220:223], v[116:119], v[52:55]
  v_mfma_f32_16x16x32_bf16 v[56:59], a[224:227], v[104:107], v[56:59]
  v_mfma_f32_16x16x32_bf16 v[60:63], a[224:227], v[108:111], v[60:63]
  v_mfma_f32_16x16x32_bf16 v[64:67], a[224:227], v[112:115], v[64:67]
  v_mfma_f32_16x16x32_bf16 v[68:71], a[224:227], v[116:119], v[68:71]
  v_mfma_f32_16x16x32_bf16 v[72:75], a[228:231], v[104:107], v[72:75]
  v_mfma_f32_16x16x32_bf16 v[76:79], a[228:231], v[108:111], v[76:79]
  s_waitcnt vmcnt(8)
  v_swap_b32 v122, v124
  v_swap_b32 v123, v125
  v_swap_b32 v130, v132
  v_swap_b32 v131, v133
  v_mfma_f32_16x16x32_bf16 v[80:83], a[228:231], v[112:115], v[80:83]
  v_mfma_f32_16x16x32_bf16 v[84:87], a[228:231], v[116:119], v[84:87]
  v_mfma_f32_16x16x32_bf16 v[88:91], a[232:235], v[104:107], v[88:91]
  v_mfma_f32_16x16x32_bf16 v[92:95], a[232:235], v[108:111], v[92:95]
  v_mfma_f32_16x16x32_bf16 v[96:99], a[232:235], v[112:115], v[96:99]
  v_mfma_f32_16x16x32_bf16 v[100:103], a[232:235], v[116:119], v[100:103]
  v_mfma_f32_16x16x32_bf16 v[24:27], a[96:99], v[120:123], v[24:27]
  s_add_u32 s71, s70, 12288
  buffer_load_dwordx4 v[104:107], v5, s[8:11], s71 offen sc1
  v_mfma_f32_16x16x32_bf16 v[28:31], a[96:99], v[124:127], v[28:31]
  v_mfma_f32_16x16x32_bf16 v[32:35], a[96:99], v[128:131], v[32:35]
  buffer_load_dwordx4 v[108:111], v5, s[8:11], s71 offen offset:1024 sc1
  v_mfma_f32_16x16x32_bf16 v[36:39], a[96:99], v[132:135], v[36:39]
  v_mfma_f32_16x16x32_bf16 v[40:43], a[100:103], v[120:123], v[40:43]
  s_add_u32 s72, s70, 122880
  buffer_load_dwordx4 v[112:115], v5, s[8:11], s72 offen sc1
  v_mfma_f32_16x16x32_bf16 v[44:47], a[100:103], v[124:127], v[44:47]
  v_mfma_f32_16x16x32_bf16 v[48:51], a[100:103], v[128:131], v[48:51]
  buffer_load_dwordx4 v[116:119], v5, s[8:11], s72 offen offset:1024 sc1
  v_mfma_f32_16x16x32_bf16 v[52:55], a[100:103], v[132:135], v[52:55]
  v_mfma_f32_16x16x32_bf16 v[56:59], a[104:107], v[120:123], v[56:59]
  v_mfma_f32_16x16x32_bf16 v[60:63], a[104:107], v[124:127], v[60:63]
  v_mfma_f32_16x16x32_bf16 v[64:67], a[104:107], v[128:131], v[64:67]
  v_mfma_f32_16x16x32_bf16 v[68:71], a[104:107], v[132:135], v[68:71]
  v_mfma_f32_16x16x32_bf16 v[72:75], a[108:111], v[120:123], v[72:75]
  v_mfma_f32_16x16x32_bf16 v[76:79], a[108:111], v[124:127], v[76:79]
  s_waitcnt vmcnt(8)
  v_swap_b32 v138, v140
  v_swap_b32 v139, v141
  v_swap_b32 v146, v148
  v_swap_b32 v147, v149
  v_mfma_f32_16x16x32_bf16 v[80:83], a[108:111], v[128:131], v[80:83]
  v_mfma_f32_16x16x32_bf16 v[84:87], a[108:111], v[132:135], v[84:87]
  v_mfma_f32_16x16x32_bf16 v[88:91], a[112:115], v[120:123], v[88:91]
  v_mfma_f32_16x16x32_bf16 v[92:95], a[112:115], v[124:127], v[92:95]
  v_mfma_f32_16x16x32_bf16 v[96:99], a[112:115], v[128:131], v[96:99]
  v_mfma_f32_16x16x32_bf16 v[100:103], a[112:115], v[132:135], v[100:103]
  v_mfma_f32_16x16x32_bf16 v[24:27], a[116:119], v[136:139], v[24:27]
  s_add_u32 s71, s70, 18432
  buffer_load_dwordx4 v[120:123], v5, s[8:11], s71 offen sc1
  v_mfma_f32_16x16x32_bf16 v[28:31], a[116:119], v[140:143], v[28:31]
  v_mfma_f32_16x16x32_bf16 v[32:35], a[116:119], v[144:147], v[32:35]
  buffer_load_dwordx4 v[124:127], v5, s[8:11], s71 offen offset:1024 sc1
  v_mfma_f32_16x16x32_bf16 v[36:39], a[116:119], v[148:151], v[36:39]
  v_mfma_f32_16x16x32_bf16 v[40:43], a[120:123], v[136:139], v[40:43]
  s_add_u32 s72, s70, 129024
  buffer_load_dwordx4 v[128:131], v5, s[8:11], s72 offen sc1
  v_mfma_f32_16x16x32_bf16 v[44:47], a[120:123], v[140:143], v[44:47]
  v_mfma_f32_16x16x32_bf16 v[48:51], a[120:123], v[144:147], v[48:51]
  buffer_load_dwordx4 v[132:135], v5, s[8:11], s72 offen offset:1024 sc1
  v_mfma_f32_16x16x32_bf16 v[52:55], a[120:123], v[148:151], v[52:55]
  v_mfma_f32_16x16x32_bf16 v[56:59], a[124:127], v[136:139], v[56:59]
  v_mfma_f32_16x16x32_bf16 v[60:63], a[124:127], v[140:143], v[60:63]
  v_mfma_f32_16x16x32_bf16 v[64:67], a[124:127], v[144:147], v[64:67]
  v_mfma_f32_16x16x32_bf16 v[68:71], a[124:127], v[148:151], v[68:71]
  v_mfma_f32_16x16x32_bf16 v[72:75], a[128:131], v[136:139], v[72:75]
  v_mfma_f32_16x16x32_bf16 v[76:79], a[128:131], v[140:143], v[76:79]
  s_waitcnt vmcnt(8)
  v_swap_b32 v154, v156
  v_swap_b32 v155, v157
  v_swap_b32 v162, v164
  v_swap_b32 v163, v165
  v_mfma_f32_16x16x32_bf16 v[80:83], a[128:131], v[144:147], v[80:83]
  v_mfma_f32_16x16x32_bf16 v[84:87], a[128:131], v[148:151], v[84:87]
  v_mfma_f32_16x16x32_bf16 v[88:91], a[132:135], v[136:139], v[88:91]
  v_mfma_f32_16x16x32_bf16 v[92:95], a[132:135], v[140:143], v[92:95]
  v_mfma_f32_16x16x32_bf16 v[96:99], a[132:135], v[144:147], v[96:99]
  v_mfma_f32_16x16x32_bf16 v[100:103], a[132:135], v[148:151], v[100:103]
  v_mfma_f32_16x16x32_bf16 v[24:27], a[156:159], v[152:155], v[24:27]
  s_add_u32 s71, s70, 20480
  buffer_load_dwordx4 v[136:139], v5, s[8:11], s71 offen sc1
  v_mfma_f32_16x16x32_bf16 v[28:31], a[156:159], v[156:159], v[28:31]
  v_mfma_f32_16x16x32_bf16 v[32:35], a[156:159], v[160:163], v[32:35]
  buffer_load_dwordx4 v[140:143], v5, s[8:11], s71 offen offset:1024 sc1
  v_mfma_f32_16x16x32_bf16 v[36:39], a[156:159], v[164:167], v[36:39]
  v_mfma_f32_16x16x32_bf16 v[40:43], a[160:163], v[152:155], v[40:43]
  s_add_u32 s72, s70, 131072
  buffer_load_dwordx4 v[144:147], v5, s[8:11], s72 offen sc1
  v_mfma_f32_16x16x32_bf16 v[44:47], a[160:163], v[156:159], v[44:47]
  v_mfma_f32_16x16x32_bf16 v[48:51], a[160:163], v[160:163], v[48:51]
  buffer_load_dwordx4 v[148:151], v5, s[8:11], s72 offen offset:1024 sc1
  v_mfma_f32_16x16x32_bf16 v[52:55], a[160:163], v[164:167], v[52:55]
  v_mfma_f32_16x16x32_bf16 v[56:59], a[164:167], v[152:155], v[56:59]
  v_mfma_f32_16x16x32_bf16 v[60:63], a[164:167], v[156:159], v[60:63]
  v_mfma_f32_16x16x32_bf16 v[64:67], a[164:167], v[160:163], v[64:67]
  v_mfma_f32_16x16x32_bf16 v[68:71], a[164:167], v[164:167], v[68:71]
  v_mfma_f32_16x16x32_bf16 v[72:75], a[168:171], v[152:155], v[72:75]
  v_mfma_f32_16x16x32_bf16 v[76:79], a[168:171], v[156:159], v[76:79]
  s_waitcnt vmcnt(8)
  v_swap_b32 v106, v108
  v_swap_b32 v107, v109
  v_swap_b32 v114, v116
  v_swap_b32 v115, v117
  v_mfma_f32_16x16x32_bf16 v[80:83], a[168:171], v[160:163], v[80:83]
  v_mfma_f32_16x16x32_bf16 v[84:87], a[168:171], v[164:167], v[84:87]
  v_mfma_f32_16x16x32_bf16 v[88:91], a[172:175], v[152:155], v[88:91]
  v_mfma_f32_16x16x32_bf16 v[92:95], a[172:175], v[156:159], v[92:95]
  v_mfma_f32_16x16x32_bf16 v[96:99], a[172:175], v[160:163], v[96:99]
  v_mfma_f32_16x16x32_bf16 v[100:103], a[172:175], v[164:167], v[100:103]
  v_mfma_f32_16x16x32_bf16 v[24:27], a[176:179], v[104:107], v[24:27]
  s_add_u32 s71, s70, 22528
  buffer_load_dwordx4 v[152:155], v5, s[8:11], s71 offen sc1
  v_mfma_f32_16x16x32_bf16 v[28:31], a[176:179], v[108:111], v[28:31]
  v_mfma_f32_16x16x32_bf16 v[32:35], a[176:179], v[112:115], v[32:35]
  buffer_load_dwordx4 v[156:159], v5, s[8:11], s71 offen offset:1024 sc1
  v_mfma_f32_16x16x32_bf16 v[36:39], a[176:179], v[116:119], v[36:39]
  v_mfma_f32_16x16x32_bf16 v[40:43], a[180:183], v[104:107], v[40:43]
  s_add_u32 s72, s70, 133120
  buffer_load_dwordx4 v[160:163], v5, s[8:11], s72 offen sc1
  v_mfma_f32_16x16x32_bf16 v[44:47], a[180:183], v[108:111], v[44:47]
  v_mfma_f32_16x16x32_bf16 v[48:51], a[180:183], v[112:115], v[48:51]
  buffer_load_dwordx4 v[164:167], v5, s[8:11], s72 offen offset:1024 sc1
  v_mfma_f32_16x16x32_bf16 v[52:55], a[180:183], v[116:119], v[52:55]
  v_mfma_f32_16x16x32_bf16 v[56:59], a[184:187], v[104:107], v[56:59]
  v_mfma_f32_16x16x32_bf16 v[60:63], a[184:187], v[108:111], v[60:63]
  v_mfma_f32_16x16x32_bf16 v[64:67], a[184:187], v[112:115], v[64:67]
  v_mfma_f32_16x16x32_bf16 v[68:71], a[184:187], v[116:119], v[68:71]
  v_mfma_f32_16x16x32_bf16 v[72:75], a[188:191], v[104:107], v[72:75]
  v_mfma_f32_16x16x32_bf16 v[76:79], a[188:191], v[108:111], v[76:79]
  s_waitcnt vmcnt(8)
  v_swap_b32 v122, v124
  v_swap_b32 v123, v125
  v_swap_b32 v130, v132
  v_swap_b32 v131, v133
  v_mfma_f32_16x16x32_bf16 v[80:83], a[188:191], v[112:115], v[80:83]
  v_mfma_f32_16x16x32_bf16 v[84:87], a[188:191], v[116:119], v[84:87]
  v_mfma_f32_16x16x32_bf16 v[88:91], a[192:195], v[104:107], v[88:91]
  v_mfma_f32_16x16x32_bf16 v[92:95], a[192:195], v[108:111], v[92:95]
  v_mfma_f32_16x16x32_bf16 v[96:99], a[192:195], v[112:115], v[96:99]
  v_mfma_f32_16x16x32_bf16 v[100:103], a[192:195], v[116:119], v[100:103]
  v_mfma_f32_16x16x32_bf16 v[24:27], a[236:239], v[120:123], v[24:27]
  s_add_u32 s71, s70, 24576
  s_add_u32 s71, s71, s77
  buffer_load_dwordx4 v[104:107], v5, s[8:11], s71 offen sc1
  v_mfma_f32_16x16x32_bf16 v[28:31], a[236:239], v[124:127], v[28:31]
  v_mfma_f32_16x16x32_bf16 v[32:35], a[236:239], v[128:131], v[32:35]
  buffer_load_dwordx4 v[108:111], v5, s[8:11], s71 offen offset:1024 sc1
  v_mfma_f32_16x16x32_bf16 v[36:39], a[236:239], v[132:135], v[36:39]
  v_mfma_f32_16x16x32_bf16 v[40:43], a[240:243], v[120:123], v[40:43]
  s_add_u32 s72, s70, 135168
  s_add_u32 s72, s72, s77
  buffer_load_dwordx4 v[112:115], v5, s[8:11], s72 offen sc1
  v_mfma_f32_16x16x32_bf16 v[44:47], a[240:243], v[124:127], v[44:47]
  v_mfma_f32_16x16x32_bf16 v[48:51], a[240:243], v[128:131], v[48:51]
  buffer_load_dwordx4 v[116:119], v5, s[8:11], s72 offen offset:1024 sc1
  v_mfma_f32_16x16x32_bf16 v[52:55], a[240:243], v[132:135], v[52:55]
  v_mfma_f32_16x16x32_bf16 v[56:59], a[244:247], v[120:123], v[56:59]
  v_mfma_f32_16x16x32_bf16 v[60:63], a[244:247], v[124:127], v[60:63]
  v_mfma_f32_16x16x32_bf16 v[64:67], a[244:247], v[128:131], v[64:67]
  v_mfma_f32_16x16x32_bf16 v[68:71], a[244:247], v[132:135], v[68:71]
  v_mfma_f32_16x16x32_bf16 v[72:75], a[248:251], v[120:123], v[72:75]
  v_mfma_f32_16x16x32_bf16 v[76:79], a[248:251], v[124:127], v[76:79]
  s_waitcnt vmcnt(8)
  v_swap_b32 v138, v140
  v_swap_b32 v139, v141
  v_swap_b32 v146, v148
  v_swap_b32 v147, v149
  v_mfma_f32_16x16x32_bf16 v[80:83], a[248:251], v[128:131], v[80:83]
  v_mfma_f32_16x16x32_bf16 v[84:87], a[248:251], v[132:135], v[84:87]
  v_mfma_f32_16x16x32_bf16 v[88:91], a[252:255], v[120:123], v[88:91]
  v_mfma_f32_16x16x32_bf16 v[92:95], a[252:255], v[124:127], v[92:95]
  v_mfma_f32_16x16x32_bf16 v[96:99], a[252:255], v[128:131], v[96:99]
  v_mfma_f32_16x16x32_bf16 v[100:103], a[252:255], v[132:135], v[100:103]
  v_mfma_f32_16x16x32_bf16 v[24:27], v[176:179], v[136:139], v[24:27]
  s_add_u32 s71, s70, 26624
  s_add_u32 s71, s71, s77
  buffer_load_dwordx4 v[120:123], v5, s[8:11], s71 offen sc1
  v_mfma_f32_16x16x32_bf16 v[28:31], v[176:179], v[140:143], v[28:31]
  v_mfma_f32_16x16x32_bf16 v[32:35], v[176:179], v[144:147], v[32:35]
  buffer_load_dwordx4 v[124:127], v5, s[8:11], s71 offen offset:1024 sc1
  v_mfma_f32_16x16x32_bf16 v[36:39], v[176:179], v[148:151], v[36:39]
  v_mfma_f32_16x16x32_bf16 v[40:43], v[180:183], v[136:139], v[40:43]
  s_add_u32 s72, s70, 137216
  s_add_u32 s72, s72, s77
  buffer_load_dwordx4 v[128:131], v5, s[8:11], s72 offen sc1
  v_mfma_f32_16x16x32_bf16 v[44:47], v[180:183], v[140:143], v[44:47]
  v_mfma_f32_16x16x32_bf16 v[48:51], v[180:183], v[144:147], v[48:51]
  buffer_load_dwordx4 v[132:135], v5, s[8:11], s72 offen offset:1024 sc1
  v_mfma_f32_16x16x32_bf16 v[52:55], v[180:183], v[148:151], v[52:55]
  v_mfma_f32_16x16x32_bf16 v[56:59], v[184:187], v[136:139], v[56:59]
  v_mfma_f32_16x16x32_bf16 v[60:63], v[184:187], v[140:143], v[60:63]
  v_mfma_f32_16x16x32_bf16 v[64:67], v[184:187], v[144:147], v[64:67]
  v_mfma_f32_16x16x32_bf16 v[68:71], v[184:187], v[148:151], v[68:71]
  v_mfma_f32_16x16x32_bf16 v[72:75], v[188:191], v[136:139], v[72:75]
  v_mfma_f32_16x16x32_bf16 v[76:79], v[188:191], v[140:143], v[76:79]
  s_waitcnt vmcnt(8)
  v_swap_b32 v154, v156
  v_swap_b32 v155, v157
  v_swap_b32 v162, v164
  v_swap_b32 v163, v165
  v_mfma_f32_16x16x32_bf16 v[80:83], v[188:191], v[144:147], v[80:83]
  v_mfma_f32_16x16x32_bf16 v[84:87], v[188:191], v[148:151], v[84:87]
  v_mfma_f32_16x16x32_bf16 v[88:91], v[192:195], v[136:139], v[88:91]
  v_mfma_f32_16x16x32_bf16 v[92:95], v[192:195], v[140:143], v[92:95]
  v_mfma_f32_16x16x32_bf16 v[96:99], v[192:195], v[144:147], v[96:99]
  v_mfma_f32_16x16x32_bf16 v[100:103], v[192:195], v[148:151], v[100:103]
  v_mfma_f32_16x16x32_bf16 v[24:27], v[196:199], v[152:155], v[24:27]
  v_mfma_f32_16x16x32_bf16 v[28:31], v[196:199], v[156:159], v[28:31]
  v_mfma_f32_16x16x32_bf16 v[32:35], v[196:199], v[160:163], v[32:35]
  v_mfma_f32_16x16x32_bf16 v[36:39], v[196:199], v[164:167], v[36:39]
  v_mfma_f32_16x16x32_bf16 v[40:43], v[200:203], v[152:155], v[40:43]
  v_mfma_f32_16x16x32_bf16 v[44:47], v[200:203], v[156:159], v[44:47]
  v_mfma_f32_16x16x32_bf16 v[48:51], v[200:203], v[160:163], v[48:51]
  v_mfma_f32_16x16x32_bf16 v[52:55], v[200:203], v[164:167], v[52:55]
  v_mfma_f32_16x16x32_bf16 v[56:59], v[204:207], v[152:155], v[56:59]
  v_mfma_f32_16x16x32_bf16 v[60:63], v[204:207], v[156:159], v[60:63]
  v_mfma_f32_16x16x32_bf16 v[64:67], v[204:207], v[160:163], v[64:67]
  v_mfma_f32_16x16x32_bf16 v[68:71], v[204:207], v[164:167], v[68:71]
  v_mfma_f32_16x16x32_bf16 v[72:75], v[208:211], v[152:155], v[72:75]
  v_mfma_f32_16x16x32_bf16 v[76:79], v[208:211], v[156:159], v[76:79]
  s_waitcnt vmcnt(4)
  v_swap_b32 v106, v108
  v_swap_b32 v107, v109
  v_swap_b32 v114, v116
  v_swap_b32 v115, v117
  v_mfma_f32_16x16x32_bf16 v[80:83], v[208:211], v[160:163], v[80:83]
  v_mfma_f32_16x16x32_bf16 v[84:87], v[208:211], v[164:167], v[84:87]
  v_mfma_f32_16x16x32_bf16 v[88:91], v[212:215], v[152:155], v[88:91]
  v_mfma_f32_16x16x32_bf16 v[92:95], v[212:215], v[156:159], v[92:95]
  v_mfma_f32_16x16x32_bf16 v[96:99], v[212:215], v[160:163], v[96:99]
  v_mfma_f32_16x16x32_bf16 v[100:103], v[212:215], v[164:167], v[100:103]
  v_mfma_f32_16x16x32_bf16 v[24:27], v[216:219], v[104:107], v[24:27]
  v_mfma_f32_16x16x32_bf16 v[28:31], v[216:219], v[108:111], v[28:31]
  v_mfma_f32_16x16x32_bf16 v[32:35], v[216:219], v[112:115], v[32:35]
  v_mfma_f32_16x16x32_bf16 v[36:39], v[216:219], v[116:119], v[36:39]
  v_mfma_f32_16x16x32_bf16 v[40:43], v[220:223], v[104:107], v[40:43]
  v_mfma_f32_16x16x32_bf16 v[44:47], v[220:223], v[108:111], v[44:47]
  v_mfma_f32_16x16x32_bf16 v[48:51], v[220:223], v[112:115], v[48:51]
  v_mfma_f32_16x16x32_bf16 v[52:55], v[220:223], v[116:119], v[52:55]
  v_mfma_f32_16x16x32_bf16 v[56:59], v[224:227], v[104:107], v[56:59]
  v_mfma_f32_16x16x32_bf16 v[60:63], v[224:227], v[108:111], v[60:63]
  v_mfma_f32_16x16x32_bf16 v[64:67], v[224:227], v[112:115], v[64:67]
  v_mfma_f32_16x16x32_bf16 v[68:71], v[224:227], v[116:119], v[68:71]
  v_mfma_f32_16x16x32_bf16 v[72:75], v[228:231], v[104:107], v[72:75]
  v_mfma_f32_16x16x32_bf16 v[76:79], v[228:231], v[108:111], v[76:79]
  s_waitcnt vmcnt(0)
  v_swap_b32 v122, v124
  v_swap_b32 v123, v125
  v_swap_b32 v130, v132
  v_swap_b32 v131, v133
  v_mfma_f32_16x16x32_bf16 v[80:83], v[228:231], v[112:115], v[80:83]
  v_mfma_f32_16x16x32_bf16 v[84:87], v[228:231], v[116:119], v[84:87]
  v_mfma_f32_16x16x32_bf16 v[88:91], v[232:235], v[104:107], v[88:91]
  v_mfma_f32_16x16x32_bf16 v[92:95], v[232:235], v[108:111], v[92:95]
  v_mfma_f32_16x16x32_bf16 v[96:99], v[232:235], v[112:115], v[96:99]
  v_mfma_f32_16x16x32_bf16 v[100:103], v[232:235], v[116:119], v[100:103]
  v_mfma_f32_16x16x32_bf16 v[24:27], v[236:239], v[120:123], v[24:27]
  v_mfma_f32_16x16x32_bf16 v[28:31], v[236:239], v[124:127], v[28:31]
  v_mfma_f32_16x16x32_bf16 v[32:35], v[236:239], v[128:131], v[32:35]
  v_mfma_f32_16x16x32_bf16 v[36:39], v[236:239], v[132:135], v[36:39]
  v_mfma_f32_16x16x32_bf16 v[40:43], v[240:243], v[120:123], v[40:43]
  v_mfma_f32_16x16x32_bf16 v[44:47], v[240:243], v[124:127], v[44:47]
  v_mfma_f32_16x16x32_bf16 v[48:51], v[240:243], v[128:131], v[48:51]
  v_mfma_f32_16x16x32_bf16 v[52:55], v[240:243], v[132:135], v[52:55]
  v_mfma_f32_16x16x32_bf16 v[56:59], v[244:247], v[120:123], v[56:59]
  v_mfma_f32_16x16x32_bf16 v[60:63], v[244:247], v[124:127], v[60:63]
  v_mfma_f32_16x16x32_bf16 v[64:67], v[244:247], v[128:131], v[64:67]
  v_mfma_f32_16x16x32_bf16 v[68:71], v[244:247], v[132:135], v[68:71]
  v_mfma_f32_16x16x32_bf16 v[72:75], v[248:251], v[120:123], v[72:75]
  v_mfma_f32_16x16x32_bf16 v[76:79], v[248:251], v[124:127], v[76:79]
  v_mfma_f32_16x16x32_bf16 v[80:83], v[248:251], v[128:131], v[80:83]
  v_mfma_f32_16x16x32_bf16 v[84:87], v[248:251], v[132:135], v[84:87]
  v_mfma_f32_16x16x32_bf16 v[88:91], v[252:255], v[120:123], v[88:91]
  v_mfma_f32_16x16x32_bf16 v[92:95], v[252:255], v[124:127], v[92:95]
  v_mfma_f32_16x16x32_bf16 v[96:99], v[252:255], v[128:131], v[96:99]
  v_mfma_f32_16x16x32_bf16 v[100:103], v[252:255], v[132:135], v[100:103]
  s_mul_i32 s64, s3, 20480
  v_add_u32 v18, s64, v5
  s_nop 6
  s_cmp_eq_u32 s3, 0
  s_cbranch_scc1 sequential_preLN__ssm_conv_s4__dense_activation_mish__prompt_kernel_skipw_27
  ds_write_b128 v18, v[24:27] offset:0
  ds_write_b128 v18, v[40:43] offset:1024
  ds_write_b128 v18, v[56:59] offset:2048
  ds_write_b128 v18, v[72:75] offset:3072
  ds_write_b128 v18, v[88:91] offset:4096
sequential_preLN__ssm_conv_s4__dense_activation_mish__prompt_kernel_skipw_27:
  s_cmp_eq_u32 s3, 1
  s_cbranch_scc1 sequential_preLN__ssm_conv_s4__dense_activation_mish__prompt_kernel_skipw_28
  ds_write_b128 v18, v[28:31] offset:5120
  ds_write_b128 v18, v[44:47] offset:6144
  ds_write_b128 v18, v[60:63] offset:7168
  ds_write_b128 v18, v[76:79] offset:8192
  ds_write_b128 v18, v[92:95] offset:9216
sequential_preLN__ssm_conv_s4__dense_activation_mish__prompt_kernel_skipw_28:
  s_cmp_eq_u32 s3, 2
  s_cbranch_scc1 sequential_preLN__ssm_conv_s4__dense_activation_mish__prompt_kernel_skipw_29
  ds_write_b128 v18, v[32:35] offset:10240
  ds_write_b128 v18, v[48:51] offset:11264
  ds_write_b128 v18, v[64:67] offset:12288
  ds_write_b128 v18, v[80:83] offset:13312
  ds_write_b128 v18, v[96:99] offset:14336
sequential_preLN__ssm_conv_s4__dense_activation_mish__prompt_kernel_skipw_29:
  s_cmp_eq_u32 s3, 3
  s_cbranch_scc1 sequential_preLN__ssm_conv_s4__dense_activation_mish__prompt_kernel_skipw_30
  ds_write_b128 v18, v[36:39] offset:15360
  ds_write_b128 v18, v[52:55] offset:16384
  ds_write_b128 v18, v[68:71] offset:17408
  ds_write_b128 v18, v[84:87] offset:18432
  ds_write_b128 v18, v[100:103] offset:19456
sequential_preLN__ssm_conv_s4__dense_activation_mish__prompt_kernel_skipw_30:
  s_cmp_lg_u32 s3, 0
  s_cbranch_scc1 sequential_preLN__ssm_conv_s4__dense_activation_mish__prompt_kernel_skipm_31
  v_pk_mov_b32 v[104:105], v[24:25], v[24:25] op_sel:[0,1]
  v_pk_mov_b32 v[106:107], v[26:27], v[26:27] op_sel:[0,1]
  v_pk_mov_b32 v[108:109], v[40:41], v[40:41] op_sel:[0,1]
  v_pk_mov_b32 v[110:111], v[42:43], v[42:43] op_sel:[0,1]
  v_pk_mov_b32 v[112:113], v[56:57], v[56:57] op_sel:[0,1]
  v_pk_mov_b32 v[114:115], v[58:59], v[58:59] op_sel:[0,1]
  v_pk_mov_b32 v[116:117], v[72:73], v[72:73] op_sel:[0,1]
  v_pk_mov_b32 v[118:119], v[74:75], v[74:75] op_sel:[0,1]
  v_pk_mov_b32 v[120:121], v[88:89], v[88:89] op_sel:[0,1]
  v_pk_mov_b32 v[122:123], v[90:91], v[90:91] op_sel:[0,1]
sequential_preLN__ssm_conv_s4__dense_activation_mish__prompt_kernel_skipm_31:
  s_cmp_lg_u32 s3, 1
  s_cbranch_scc1 sequential_preLN__ssm_conv_s4__dense_activation_mish__prompt_kernel_skipm_32
  v_pk_mov_b32 v[104:105], v[28:29], v[28:29] op_sel:[0,1]
  v_pk_mov_b32 v[106:107], v[30:31], v[30:31] op_sel:[0,1]
  v_pk_mov_b32 v[108:109], v[44:45], v[44:45] op_sel:[0,1]
  v_pk_mov_b32 v[110:111], v[46:47], v[46:47] op_sel:[0,1]
  v_pk_mov_b32 v[112:113], v[60:61], v[60:61] op_sel:[0,1]
  v_pk_mov_b32 v[114:115], v[62:63], v[62:63] op_sel:[0,1]
  v_pk_mov_b32 v[116:117], v[76:77], v[76:77] op_sel:[0,1]
  v_pk_mov_b32 v[118:119], v[78:79], v[78:79] op_sel:[0,1]
  v_pk_mov_b32 v[120:121], v[92:93], v[92:93] op_sel:[0,1]
  v_pk_mov_b32 v[122:123], v[94:95], v[94:95] op_sel:[0,1]
sequential_preLN__ssm_conv_s4__dense_activation_mish__prompt_kernel_skipm_32:
  s_cmp_lg_u32 s3, 2
  s_cbranch_scc1 sequential_preLN__ssm_conv_s4__dense_activation_mish__prompt_kernel_skipm_33
  v_pk_mov_b32 v[104:105], v[32:33], v[32:33] op_sel:[0,1]
  v_pk_mov_b32 v[106:107], v[34:35], v[34:35] op_sel:[0,1]
  v_pk_mov_b32 v[108:109], v[48:49], v[48:49] op_sel:[0,1]
  v_pk_mov_b32 v[110:111], v[50:51], v[50:51] op_sel:[0,1]
  v_pk_mov_b32 v[112:113], v[64:65], v[64:65] op_sel:[0,1]
  v_pk_mov_b32 v[114:115], v[66:67], v[66:67] op_sel:[0,1]
  v_pk_mov_b32 v[116:117], v[80:81], v[80:81] op_sel:[0,1]
  v_pk_mov_b32 v[118:119], v[82:83], v[82:83] op_sel:[0,1]
  v_pk_mov_b32 v[120:121], v[96:97], v[96:97] op_sel:[0,1]
  v_pk_mov_b32 v[122:123], v[98:99], v[98:99] op_sel:[0,1]
sequential_preLN__ssm_conv_s4__dense_activation_mish__prompt_kernel_skipm_33:
  s_cmp_lg_u32 s3, 3
  s_cbranch_scc1 sequential_preLN__ssm_conv_s4__dense_activation_mish__prompt_kernel_skipm_34
  v_pk_mov_b32 v[104:105], v[36:37], v[36:37] op_sel:[0,1]
  v_pk_mov_b32 v[106:107], v[38:39], v[38:39] op_sel:[0,1]
  v_pk_mov_b32 v[108:109], v[52:53], v[52:53] op_sel:[0,1]
  v_pk_mov_b32 v[110:111], v[54:55], v[54:55] op_sel:[0,1]
  v_pk_mov_b32 v[112:113], v[68:69], v[68:69] op_sel:[0,1]
  v_pk_mov_b32 v[114:115], v[70:71], v[70:71] op_sel:[0,1]
  v_pk_mov_b32 v[116:117], v[84:85], v[84:85] op_sel:[0,1]
  v_pk_mov_b32 v[118:119], v[86:87], v[86:87] op_sel:[0,1]
  v_pk_mov_b32 v[120:121], v[100:101], v[100:101] op_sel:[0,1]
  v_pk_mov_b32 v[122:123], v[102:103], v[102:103] op_sel:[0,1]
sequential_preLN__ssm_conv_s4__dense_activation_mish__prompt_kernel_skipm_34:
  s_waitcnt lgkmcnt(0)
  s_barrier
  s_add_u32 s64, s3, 1
  s_and_b32 s64, s64, 3
  s_mul_i32 s64, s64, 20480
  s_mul_i32 s65, s3, 5120
  s_add_u32 s64, s64, s65
  v_add_u32 v18, s64, v5
  ds_read_b128 v[124:127], v18 offset:0
  ds_read_b128 v[128:131], v18 offset:1024
  ds_read_b128 v[132:135], v18 offset:2048
  ds_read_b128 v[136:139], v18 offset:3072
  ds_read_b128 v[140:143], v18 offset:4096
  s_add_u32 s64, s3, 2
  s_and_b32 s64, s64, 3
  s_mul_i32 s64, s64, 20480
  s_mul_i32 s65, s3, 5120
  s_add_u32 s64, s64, s65
  v_add_u32 v18, s64, v5
  ds_read_b128 v[144:147], v18 offset:0
  ds_read_b128 v[148:151], v18 offset:1024
  ds_read_b128 v[152:155], v18 offset:2048
  ds_read_b128 v[156:159], v18 offset:3072
  ds_read_b128 v[160:163], v18 offset:4096
  s_add_u32 s64, s3, 3
  s_and_b32 s64, s64, 3
  s_mul_i32 s64, s64, 20480
  s_mul_i32 s65, s3, 5120
  s_add_u32 s64, s64, s65
  v_add_u32 v18, s64, v5
  ds_read_b128 v[164:167], v18 offset:0
  ds_read_b128 v[168:171], v18 offset:1024
  ds_read_b128 v[172:175], v18 offset:2048
  ds_read_b128 v[176:179], v18 offset:3072
  ds_read_b128 v[180:183], v18 offset:4096
  s_waitcnt lgkmcnt(0)
  v_pk_add_f32 v[104:105], v[104:105], v[124:125]
  v_pk_add_f32 v[106:107], v[106:107], v[126:127]
  v_pk_add_f32 v[108:109], v[108:109], v[128:129]
  v_pk_add_f32 v[110:111], v[110:111], v[130:131]
  v_pk_add_f32 v[112:113], v[112:113], v[132:133]
  v_pk_add_f32 v[114:115], v[114:115], v[134:135]
  v_pk_add_f32 v[116:117], v[116:117], v[136:137]
  v_pk_add_f32 v[118:119], v[118:119], v[138:139]
  v_pk_add_f32 v[120:121], v[120:121], v[140:141]
  v_pk_add_f32 v[122:123], v[122:123], v[142:143]
  v_pk_add_f32 v[104:105], v[104:105], v[144:145]
  v_pk_add_f32 v[106:107], v[106:107], v[146:147]
  v_pk_add_f32 v[108:109], v[108:109], v[148:149]
  v_pk_add_f32 v[110:111], v[110:111], v[150:151]
  v_pk_add_f32 v[112:113], v[112:113], v[152:153]
  v_pk_add_f32 v[114:115], v[114:115], v[154:155]
  v_pk_add_f32 v[116:117], v[116:117], v[156:157]
  v_pk_add_f32 v[118:119], v[118:119], v[158:159]
  v_pk_add_f32 v[120:121], v[120:121], v[160:161]
  v_pk_add_f32 v[122:123], v[122:123], v[162:163]
  v_pk_add_f32 v[104:105], v[104:105], v[164:165]
  v_pk_add_f32 v[106:107], v[106:107], v[166:167]
  v_pk_add_f32 v[108:109], v[108:109], v[168:169]
  v_pk_add_f32 v[110:111], v[110:111], v[170:171]
  v_pk_add_f32 v[112:113], v[112:113], v[172:173]
  v_pk_add_f32 v[114:115], v[114:115], v[174:175]
  v_pk_add_f32 v[116:117], v[116:117], v[176:177]
  v_pk_add_f32 v[118:119], v[118:119], v[178:179]
  v_pk_add_f32 v[120:121], v[120:121], v[180:181]
  v_pk_add_f32 v[122:123], v[122:123], v[182:183]
  v_lshlrev_b32 v18, 16, v8
  v_and_b32 v19, 0xffff0000, v8
  v_pk_add_f32 v[104:105], v[104:105], v[18:19]
  v_lshlrev_b32 v18, 16, v9
  v_and_b32 v19, 0xffff0000, v9
  v_pk_add_f32 v[106:107], v[106:107], v[18:19]
  v_lshlrev_b32 v18, 16, v10
  v_and_b32 v19, 0xffff0000, v10
  v_pk_add_f32 v[108:109], v[108:109], v[18:19]
  v_lshlrev_b32 v18, 16, v11
  v_and_b32 v19, 0xffff0000, v11
  v_pk_add_f32 v[110:111], v[110:111], v[18:19]
  v_lshlrev_b32 v18, 16, v12
  v_and_b32 v19, 0xffff0000, v12
  v_pk_add_f32 v[112:113], v[112:113], v[18:19]
  v_lshlrev_b32 v18, 16, v13
  v_and_b32 v19, 0xffff0000, v13
  v_pk_add_f32 v[114:115], v[114:115], v[18:19]
  v_lshlrev_b32 v18, 16, v14
  v_and_b32 v19, 0xffff0000, v14
  v_pk_add_f32 v[116:117], v[116:117], v[18:19]
  v_lshlrev_b32 v18, 16, v15
  v_and_b32 v19, 0xffff0000, v15
  v_pk_add_f32 v[118:119], v[118:119], v[18:19]
  v_lshlrev_b32 v18, 16, v16
  v_and_b32 v19, 0xffff0000, v16
  v_pk_add_f32 v[120:121], v[120:121], v[18:19]
  v_lshlrev_b32 v18, 16, v17
  v_and_b32 v19, 0xffff0000, v17
  v_pk_add_f32 v[122:123], v[122:123], v[18:19]
  v_cvt_pk_bf16_f32 v24, v104, v105
  v_cvt_pk_bf16_f32 v25, v106, v107
  v_cvt_pk_bf16_f32 v26, v108, v109
  v_cvt_pk_bf16_f32 v27, v110, v111
  v_cvt_pk_bf16_f32 v28, v112, v113
  v_cvt_pk_bf16_f32 v29, v114, v115
  v_cvt_pk_bf16_f32 v30, v116, v117
  v_cvt_pk_bf16_f32 v31, v118, v119
  v_cvt_pk_bf16_f32 v32, v120, v121
  v_cvt_pk_bf16_f32 v33, v122, v123
  s_lshl_b32 s64, s6, 1
  s_lshr_b32 s65, s3, 1
  s_add_u32 s64, s64, s65
  s_lshl_b32 s64, s64, 5
  s_and_b32 s65, s3, 1
  s_add_u32 s64, s64, s65
  s_mul_i32 s64, s64, 1280
  s_mul_i32 s65, s7, 160
  s_add_u32 s64, s64, s65
  v_mul_u32_u24 v18, 2560, v2
  v_lshl_add_u32 v19, v3, 4, v18
  v_lshl_add_u32 v20, v3, 3, v18
  buffer_store_dwordx4 v[24:27], v19, s[20:23], s64 offen nt
  buffer_store_dwordx4 v[28:31], v19, s[20:23], s64 offen offset:64 nt
  buffer_store_dwordx2 v[32:33], v20, s[20:23], s64 offen offset:128 nt
mk_end:
  s_endpgm
g1_redo:
  s_add_u32 s71, s71, 1
  s_cmp_gt_u32 s71, 20000
  s_cbranch_scc1 g1_ok
  s_sleep 8
  s_branch g1_retry
g2_slowB:
  s_mov_b32 s66, 0
g2_slowBl:
  s_sleep 1
  buffer_load_dword v4, v23, s[8:11], s69 offen sc1
  s_add_u32 s66, s66, 1
  s_waitcnt vmcnt(0)
  v_cmp_eq_u32 vcc, 0, v4
  s_cmp_gt_u32 s66, 400000
  s_cbranch_scc1 g2_okB
  s_cbranch_vccnz g2_slowBl
  s_branch g2_okB
mk_codeend:
.section .rodata,"a"
.p2align 6
.amdhsa_kernel sequential_preLN__ssm_conv_s4__dense_activation_mish__prompt_kernel
  .amdhsa_next_free_vgpr 512
  .amdhsa_next_free_sgpr 102
  .amdhsa_accum_offset 256
  .amdhsa_group_segment_fixed_size 0
  .amdhsa_kernarg_size 128
  .amdhsa_user_sgpr_count 2
  .amdhsa_user_sgpr_kernarg_segment_ptr 1
  .amdhsa_system_sgpr_workgroup_id_x 1
.end_amdhsa_kernel
```
